```python
import torch

def _softmax(x, axis=-1):
    return torch.softmax(x, dim=axis)
def _gelu(x):
    return torch.nn.functional.gelu(x, approximate="tanh")
def _silu(x):
    return torch.nn.functional.silu(x)
def _sigmoid(x):
    return torch.sigmoid(x)
def _layernorm(x, axis=-1, eps=1e-5):
    m = x.mean(dim=axis, keepdim=True)
    v = x.var(dim=axis, keepdim=True, unbiased=False)
    return (x - m) / torch.sqrt(v + eps)
def _scatter_add(tgt, idx, src, axis=0):
    return tgt.clone().index_add_(axis, idx, src)
def _segment_sum(src, seg, n):
    out = torch.zeros((n,) + src.shape[1:], dtype=src.dtype)
    return out.index_add_(0, seg, src)
def _pad(x, pw):
    flat = tuple(v for pair in reversed(pw) for v in pair)
    return torch.nn.functional.pad(x, flat)

kernel_name = 'interleave_layers__ssm_conv_s4__dense_activation_squared_relu__prompt'

def setup_inputs():

    _w = (lambda a: (lambda t: t.to(torch.bfloat16) if t.is_floating_point() else t)(torch.as_tensor(a)))
    def _A_setup():
        B, L, D, N = 1, 2048, 512, 128
        A_re = -(lambda _x: torch.exp(torch.as_tensor(_x)))((lambda *s: torch.randn(*s, dtype=torch.bfloat16) * 1.6)(D, N))
        A_im = torch.pi * (lambda *s: torch.randn(*s, dtype=torch.bfloat16) * 0.2)(D, N)
        B_re = (lambda *s: torch.randn(*s, dtype=torch.bfloat16) * 0.2)(D, N)
        B_im = (lambda *s: torch.randn(*s, dtype=torch.bfloat16) * 0.2)(D, N)
        C_re = (lambda *s: torch.randn(*s, dtype=torch.bfloat16) * 0.2)(D, N)
        C_im = (lambda *s: torch.randn(*s, dtype=torch.bfloat16) * 0.2)(D, N)
        log_dt = (lambda *s: torch.randn(*s, dtype=torch.bfloat16) * 0.2)(D) * 0.5 - 4.0
        Dskip = (lambda *s: torch.randn(*s, dtype=torch.bfloat16) * 0.2)(D)
        return {
            "u": _w((lambda *s: torch.randn(*s, dtype=torch.bfloat16) * 0.05)(B, L, D)),
            "A_re": _w(A_re),
            "A_im": _w(A_im),
            "B_re": _w(B_re),
            "B_im": _w(B_im),
            "C_re": _w(C_re),
            "C_im": _w(C_im),
            "log_dt": _w(log_dt),
            "Dskip": _w(Dskip),
        }
    _A_in = _A_setup()

    def _B_setup():
        B, S, D, F = 1, 2048, 512, 1792
        return {
            "x": _w((lambda *s: torch.randn(*s, dtype=torch.bfloat16) * 0.05)(B, S, D)),
            "w1": _w((lambda *s: torch.randn(*s, dtype=torch.bfloat16) * 0.05)(D, F)),
            "b1": _w((lambda *s: torch.randn(*s, dtype=torch.bfloat16) * 0.2)(F)),
            "w2": _w((lambda *s: torch.randn(*s, dtype=torch.bfloat16) * 0.05)(F, D)),
            "b2": _w((lambda *s: torch.randn(*s, dtype=torch.bfloat16) * 0.8)(D)),
        }
    _B_in = _B_setup()

    return {
        "A_u": _A_in["u"],
        "A_A_re": _A_in["A_re"],
        "A_A_im": _A_in["A_im"],
        "A_B_re": _A_in["B_re"],
        "A_B_im": _A_in["B_im"],
        "A_C_re": _A_in["C_re"],
        "A_C_im": _A_in["C_im"],
        "A_log_dt": _A_in["log_dt"],
        "A_Dskip": _A_in["Dskip"],
        "B_x": _B_in["x"],
        "B_w1": _B_in["w1"],
        "B_b1": _B_in["b1"],
        "B_w2": _B_in["w2"],
        "B_b2": _B_in["b2"],
    }

def reference(A_u, A_A_re, A_A_im, A_B_re, A_B_im, A_C_re, A_C_im, A_log_dt, A_Dskip, B_x, B_w1, B_b1, B_w2, B_b2):
    def _A_ref(u, A_re, A_im, B_re, B_im, C_re, C_im, log_dt, Dskip):
        Bsz, L, D = u.shape
        dt = torch.exp(log_dt)[:, None]
        A = A_re + 1j * A_im
        Bc = B_re + 1j * B_im
        Cc = C_re + 1j * C_im
        logdA = dt * A
        dB = dt * Bc
        l = (lambda x, dt: x.to(dt))(torch.arange(L), A_re.dtype)
        P = torch.exp(logdA[:, :, None] * l[None, None, :])
        K = torch.einsum("dn,dnl,dn->dl", Cc, P, dB).real
        L2 = 2 * L
        Kp = _pad(K, ((0, 0), (0, L)))
        up = (lambda x, *d: x.permute(*d))(u, 0, 2, 1)
        up = _pad(up, ((0, 0), (0, 0), (0, L)))
        Kf = (lambda x, axes=(-2,-1): torch.fft.rfft2(x.float(), dim=axes))(Kp[:, None, :], axes=(-2, -1))
        Uf = (lambda x, axes=(-2,-1): torch.fft.rfft2(x.float(), dim=axes))(up[:, :, None, :], axes=(-2, -1))
        Yf = Uf * Kf[None, :, :, :]
        y = (lambda x, s, axes=(-2,-1): torch.fft.irfft2(x, s=s, dim=axes).to(torch.bfloat16))(Yf, (1, L2), axes=(-2, -1))[:, :, 0, :L]
        y = (lambda x, *d: x.permute(*d))(y, 0, 2, 1) + u * Dskip[None, None, :]
        return y

    def _B_ref(x, w1, b1, w2, b2):
        h = torch.einsum("bsd,df->bsf", x, w1) + b1
        zero = torch.zeros_like(h)
        r = torch.where(h > zero, h, zero)
        h = r * r
        out = torch.einsum("bsf,fd->bsd", h, w2) + b2
        return out

    x = A_u
    x = x + _A_ref(_layernorm(x, axis=-1), A_A_re, A_A_im, A_B_re, A_B_im, A_C_re, A_C_im, A_log_dt, A_Dskip)
    x = x + _B_ref(_layernorm(x, axis=-1), B_w1, B_b1, B_w2, B_b2)
    x = x + _A_ref(_layernorm(x, axis=-1), A_A_re, A_A_im, A_B_re, A_B_im, A_C_re, A_C_im, A_log_dt, A_Dskip)
    x = x + _B_ref(_layernorm(x, axis=-1), B_w1, B_b1, B_w2, B_b2)
    return x
```

```asm
; @launch grid=(256,1,1) block=(256,1,1) lds=163840
.amdgcn_target "amdgcn-amd-amdhsa--gfx950"
.text
.globl interleave_layers__ssm_conv_s4__dense_activation_squared_relu__prompt_kernel
.p2align 8
.type interleave_layers__ssm_conv_s4__dense_activation_squared_relu__prompt_kernel,@function
interleave_layers__ssm_conv_s4__dense_activation_squared_relu__prompt_kernel:
    s_cmp_ge_u32 s2, 256
    s_cbranch_scc1 L_mega_end
    s_load_dwordx16 s[56:71], s[0:1], 0
    s_load_dwordx8 s[72:79], s[0:1], 80
    s_load_dwordx2 s[4:5], s[0:1], 128
    s_load_dwordx2 s[6:7], s[0:1], 64
    s_load_dwordx4 s[80:83], s[0:1], 112
    v_and_b32 v1, 63, v0
    v_lshrrev_b32 v2, 6, v0
    v_lshlrev_b32 v8, 4, v1
    s_lshr_b32 s17, s2, 3
    v_readfirstlane_b32 s33, v2
    s_lshl_b32 s3, s2, 9
    v_lshlrev_b32 v2, 1, v0
    v_add_u32 v2, s3, v2
    v_lshrrev_b32 v3, 7, v0
    s_lshl_b32 s3, s2, 2
    v_lshl_add_u32 v3, v3, 1, s3
    s_waitcnt lgkmcnt(0)
    s_mov_b32 s8, s4
    s_mov_b32 s9, s5
    s_mov_b32 s10, 32243712
    s_mov_b32 s11, 0x00020000
    s_cmp_lg_u32 s2, 255
    s_cbranch_scc1 L_nz
    v_lshlrev_b32 v4, 11, v0
    v_mov_b32 v5, 0
    s_mov_b32 s18, 31719424
    buffer_store_dword v5, v4, s[8:11], s18 offen sc1
L_nz:
    global_load_ushort v142, v3, s[70:71]
    global_load_ushort v136, v2, s[58:59]
    global_load_ushort v137, v2, s[60:61]
    global_load_ushort v138, v2, s[62:63]
    global_load_ushort v139, v2, s[64:65]
    global_load_ushort v140, v2, s[66:67]
    global_load_ushort v141, v2, s[68:69]
    v_lshrrev_b32 v4, 4, v1
    v_and_b32 v5, 15, v1
    s_cmp_ge_u32 s2, 128
    s_cbranch_scc1 L_task_w
    s_mov_b32 s20, s56
    s_mov_b32 s21, s57
    s_mov_b32 s22, 2097152
    s_mov_b32 s23, 0x00020000
    s_lshr_b32 s29, s2, 2
    s_and_b32 s30, s2, 3
    v_lshlrev_b32 v9, 2, v4
    v_xor_b32 v9, v9, v5
    v_lshlrev_b32 v9, 4, v9
    v_lshl_add_u32 v9, v4, 10, v9
    s_lshl_b32 s18, s29, 16
    s_lshl_b32 s19, s33, 14
    s_add_u32 s18, s18, s19
    s_lshl_b32 s19, s30, 8
    s_add_u32 s18, s18, s19
    s_lshl_b32 s19, s33, 12
    s_lshl_b32 s31, s2, 14
    s_add_u32 s31, s31, s19
    s_add_u32 m0, s19, 66560
    s_add_u32 s32, s18, 0
    buffer_load_dwordx4 v9, s[20:23], s32 offen lds
    s_add_u32 m0, s19, 67584
    s_add_u32 s32, s18, 4096
    buffer_load_dwordx4 v9, s[20:23], s32 offen lds
    s_add_u32 m0, s19, 68608
    s_add_u32 s32, s18, 8192
    buffer_load_dwordx4 v9, s[20:23], s32 offen lds
    s_add_u32 m0, s19, 69632
    s_add_u32 s32, s18, 12288
    buffer_load_dwordx4 v9, s[20:23], s32 offen lds
    buffer_load_dwordx4 v[120:123], v8, s[20:23], s31 offen offset:0
    buffer_load_dwordx4 v[124:127], v8, s[20:23], s31 offen offset:1024
    buffer_load_dwordx4 v[128:131], v8, s[20:23], s31 offen offset:2048
    buffer_load_dwordx4 v[132:135], v8, s[20:23], s31 offen offset:3072
    s_branch L_task_issued
L_task_w:
    s_cmp_ge_u32 s2, 192
    s_cselect_b32 s20, s76, s72
    s_cselect_b32 s21, s77, s73
    s_mov_b32 s22, 1835008
    s_mov_b32 s23, 0x00020000
    s_movk_i32 s31, 3584
    s_cselect_b32 s31, 1024, s31
    s_cselect_b32 s32, 64, 56
    s_movk_i32 s19, 128
    s_cselect_b32 s19, 192, s19
    s_sub_u32 s29, s2, s19
    s_lshr_b32 s19, s29, 2
    s_and_b32 s30, s29, 3
    s_cmp_ge_u32 s2, 192
    s_cselect_b32 s29, s29, s19
    s_cselect_b32 s30, 0, s30
    s_lshl_b32 s18, s29, 5
    s_lshl_b32 s19, s33, 3
    s_add_u32 s18, s18, s19
    s_mul_i32 s18, s18, s31
    s_mul_i32 s19, s30, 896
    s_add_u32 s18, s18, s19
    s_cmp_ge_u32 s2, 248
    s_cselect_b32 s18, 2130706432, s18
    s_lshl_b32 s19, s33, 13
    v_mov_b32 v10, 2130706432
    v_xor_b32 v9, 0, v1
    v_cmp_gt_u32 vcc, s32, v9
    v_lshlrev_b32 v9, 4, v9
    s_add_u32 m0, s19, 66560
    v_cndmask_b32 v9, v10, v9, vcc
    buffer_load_dwordx4 v9, s[20:23], s18 offen lds
    s_add_u32 s18, s18, s31
    v_xor_b32 v9, 2, v1
    v_cmp_gt_u32 vcc, s32, v9
    v_lshlrev_b32 v9, 4, v9
    s_add_u32 m0, s19, 67584
    v_cndmask_b32 v9, v10, v9, vcc
    buffer_load_dwordx4 v9, s[20:23], s18 offen lds
    s_add_u32 s18, s18, s31
    v_xor_b32 v9, 4, v1
    v_cmp_gt_u32 vcc, s32, v9
    v_lshlrev_b32 v9, 4, v9
    s_add_u32 m0, s19, 68608
    v_cndmask_b32 v9, v10, v9, vcc
    buffer_load_dwordx4 v9, s[20:23], s18 offen lds
    s_add_u32 s18, s18, s31
    v_xor_b32 v9, 6, v1
    v_cmp_gt_u32 vcc, s32, v9
    v_lshlrev_b32 v9, 4, v9
    s_add_u32 m0, s19, 69632
    v_cndmask_b32 v9, v10, v9, vcc
    buffer_load_dwordx4 v9, s[20:23], s18 offen lds
    s_add_u32 s18, s18, s31
    v_xor_b32 v9, 8, v1
    v_cmp_gt_u32 vcc, s32, v9
    v_lshlrev_b32 v9, 4, v9
    s_add_u32 m0, s19, 70656
    v_cndmask_b32 v9, v10, v9, vcc
    buffer_load_dwordx4 v9, s[20:23], s18 offen lds
    s_add_u32 s18, s18, s31
    v_xor_b32 v9, 10, v1
    v_cmp_gt_u32 vcc, s32, v9
    v_lshlrev_b32 v9, 4, v9
    s_add_u32 m0, s19, 71680
    v_cndmask_b32 v9, v10, v9, vcc
    buffer_load_dwordx4 v9, s[20:23], s18 offen lds
    s_add_u32 s18, s18, s31
    v_xor_b32 v9, 12, v1
    v_cmp_gt_u32 vcc, s32, v9
    v_lshlrev_b32 v9, 4, v9
    s_add_u32 m0, s19, 72704
    v_cndmask_b32 v9, v10, v9, vcc
    buffer_load_dwordx4 v9, s[20:23], s18 offen lds
    s_add_u32 s18, s18, s31
    v_xor_b32 v9, 14, v1
    v_cmp_gt_u32 vcc, s32, v9
    v_lshlrev_b32 v9, 4, v9
    s_add_u32 m0, s19, 73728
    v_cndmask_b32 v9, v10, v9, vcc
    buffer_load_dwordx4 v9, s[20:23], s18 offen lds
L_task_issued:
    s_getpc_b64 s[36:37]
L_pc:
    s_add_u32 s36, s36, interleave_layers__ssm_conv_s4__dense_activation_squared_relu__prompt_kernel-L_pc
    s_addc_u32 s37, s37, -1
    s_lshl_b32 s18, s17, 2
    s_add_u32 s18, s18, s33
    s_and_b32 s18, s18, 31
    s_min_u32 s18, s18, (L_mega_end-interleave_layers__ssm_conv_s4__dense_activation_squared_relu__prompt_kernel)/1024-1
    s_lshl_b32 s18, s18, 10
    v_add_u32 v2, s18, v8
    global_load_dwordx4 v[156:159], v2, s[36:37]
    v_lshlrev_b32 v2, 6, v1
    v_min_u32 v3, 3580, v2
    global_load_dword v155, v3, s[74:75]
    v_min_u32 v3, 1020, v2
    global_load_dword v154, v3, s[78:79]
    s_and_b32 s16, s2, 7
    s_mov_b32 s40, 0
    s_mov_b32 s41, 0
    s_mov_b32 s42, 23724032
    s_mov_b32 s43, 2097152
    s_mov_b32 s44, 31850496
    s_mov_b32 s45, 23805952
    s_mov_b32 s46, 8388608
    s_lshr_b32 s25, s33, 1
    s_and_b32 s28, s33, 1
    s_lshl_b32 s3, s2, 2
    s_load_dword s48, s[6:7], s3
    s_and_b32 s18, s17, 3
    s_lshr_b32 s50, s16, 1
    s_lshl_b32 s50, s50, 2
    s_add_u32 s50, s50, s18
    s_lshr_b32 s51, s17, 2
    s_min_u32 s51, s51, 6
    s_and_b32 s18, s16, 1
    s_mul_i32 s18, s18, 7
    s_add_u32 s51, s51, s18
    s_lshl_b32 s51, s51, 2
    s_add_u32 s51, s51, s33
    s_lshl_b32 s49, s51, 15
    s_add_u32 s49, s49, 15728640
    s_and_b32 s18, s17, 3
    s_lshl_b32 s52, s16, 2
    s_add_u32 s52, s52, s18
    s_lshr_b32 s53, s17, 2
    s_mul_i32 s18, s33, 57344
    s_mul_i32 s26, s53, 229376
    s_add_u32 s26, s26, s18
    s_add_u32 s26, s26, 17563648
    s_and_b32 s27, s2, 15
    s_lshl_b32 s27, s27, 11
    s_mov_b32 s12, s80
    s_mov_b32 s13, s81
    s_mov_b32 s14, 2097152
    s_mov_b32 s15, 0x00020000
    s_mov_b32 s84, s82
    s_mov_b32 s85, s83
    s_mov_b32 s86, 256
    s_mov_b32 s87, 0x00020000
    s_mov_b64 s[98:99], s[78:79]
    s_mov_b64 s[96:97], s[74:75]
    v_lshlrev_b32 v11, 3, v0
    v_sub_u32 v11, 2047, v11
    v_cvt_f32_i32 v11, v11
    v_mov_b32 v100, v11
    v_subrev_f32 v101, 0x3f800000, v11
    v_subrev_f32 v102, 0x40000000, v11
    v_subrev_f32 v103, 0x40400000, v11
    v_subrev_f32 v104, 0x40800000, v11
    v_subrev_f32 v105, 0x40a00000, v11
    v_subrev_f32 v106, 0x40c00000, v11
    v_subrev_f32 v107, 0x40e00000, v11
    v_subrev_f32 v108, 0x41000000, v11
    v_subrev_f32 v109, 0x41100000, v11
    v_subrev_f32 v110, 0x41200000, v11
    v_subrev_f32 v111, 0x41300000, v11
    v_subrev_f32 v112, 0x41400000, v11
    v_subrev_f32 v113, 0x41500000, v11
    v_subrev_f32 v114, 0x41600000, v11
    v_cvt_pk_bf16_f32 v12, v100, v101
    v_cvt_pk_bf16_f32 v13, v102, v103
    v_cvt_pk_bf16_f32 v14, v104, v105
    v_cvt_pk_bf16_f32 v15, v106, v107
    v_cvt_pk_bf16_f32 v16, v108, v109
    v_cvt_pk_bf16_f32 v17, v110, v111
    v_cvt_pk_bf16_f32 v18, v112, v113
    v_cvt_pk_bf16_f32 v19, v114, v114
    v_lshlrev_b32 v100, 16, v12
    v_and_b32 v101, 0xffff0000, v12
    v_lshlrev_b32 v102, 16, v13
    v_and_b32 v103, 0xffff0000, v13
    v_lshlrev_b32 v104, 16, v14
    v_and_b32 v105, 0xffff0000, v14
    v_lshlrev_b32 v106, 16, v15
    v_and_b32 v107, 0xffff0000, v15
    v_lshlrev_b32 v108, 16, v16
    v_and_b32 v109, 0xffff0000, v16
    v_lshlrev_b32 v110, 16, v17
    v_and_b32 v111, 0xffff0000, v17
    v_lshlrev_b32 v112, 16, v18
    v_and_b32 v113, 0xffff0000, v18
    v_lshlrev_b32 v114, 16, v19
    v_cvt_i32_f32 v100, v100
    v_cvt_i32_f32 v101, v101
    v_cvt_i32_f32 v102, v102
    v_cvt_i32_f32 v103, v103
    v_cvt_i32_f32 v104, v104
    v_cvt_i32_f32 v105, v105
    v_cvt_i32_f32 v106, v106
    v_cvt_i32_f32 v107, v107
    v_cvt_i32_f32 v108, v108
    v_cvt_i32_f32 v109, v109
    v_cvt_i32_f32 v110, v110
    v_cvt_i32_f32 v111, v111
    v_cvt_i32_f32 v112, v112
    v_cvt_i32_f32 v113, v113
    v_cvt_i32_f32 v114, v114
    s_mov_b32 s18, 102432
    v_lshl_add_u32 v100, v100, 1, s18
    v_lshl_add_u32 v101, v101, 1, s18
    v_lshl_add_u32 v102, v102, 1, s18
    v_lshl_add_u32 v103, v103, 1, s18
    v_lshl_add_u32 v104, v104, 1, s18
    v_lshl_add_u32 v105, v105, 1, s18
    v_lshl_add_u32 v106, v106, 1, s18
    v_lshl_add_u32 v107, v107, 1, s18
    v_lshl_add_u32 v108, v108, 1, s18
    v_lshl_add_u32 v109, v109, 1, s18
    v_lshl_add_u32 v110, v110, 1, s18
    v_lshl_add_u32 v111, v111, 1, s18
    v_lshl_add_u32 v112, v112, 1, s18
    v_lshl_add_u32 v113, v113, 1, s18
    v_lshl_add_u32 v114, v114, 1, s18
    s_waitcnt vmcnt(11)
    s_cmp_lg_u32 s2, 255
    s_cbranch_scc1 L_z_1
    s_barrier
    s_cmp_lg_u32 s33, 0
    s_cbranch_scc1 L_z_1
    v_mov_b32 v2, 1
    v_mov_b32 v3, 0
    s_mov_b64 exec, 1
    buffer_store_dword v2, v3, s[84:87], 0 offen sc1
    s_mov_b64 exec, -1
L_z_1:
    v_lshrrev_b32 v4, 7, v0
    s_mul_i32 s18, s25, 27984
    s_lshl_b32 s19, s28, 8
    s_add_u32 m0, s18, s19
    v_mul_u32_u24 v10, 4640, v4
    v_and_b32 v7, 7, v0
    v_lshl_add_u32 v10, v7, 2, v10
    v_add_u32 v10, 102400, v10
    v_mov_b32 v7, 0
    ds_write_b32 v10, v7
    v_lshlrev_b32 v10, 16, v136
    v_lshlrev_b32 v11, 16, v137
    v_lshlrev_b32 v12, 16, v138
    v_lshlrev_b32 v13, 16, v139
    v_lshlrev_b32 v14, 16, v140
    v_lshlrev_b32 v15, 16, v141
    v_lshlrev_b32 v16, 16, v142
    v_mul_f32 v16, 0x3fb8aa3b, v16
    v_exp_f32 v16, v16
    s_nop 0
    v_cvt_pk_bf16_f32 v16, v16, v16
    v_lshlrev_b32 v16, 16, v16
    v_mul_f32 v10, v16, v10
    v_mul_f32 v11, v16, v11
    v_mul_f32 v12, v16, v12
    v_mul_f32 v13, v16, v13
    v_mul_f32 v10, 0x3fb8aa3b, v10
    v_mul_f32 v11, 0x3e22f983, v11
    v_mul_f32 v26, 0x41000000, v10
    v_mul_f32 v27, 0x43800000, v10
    v_mul_f32 v28, 0x41000000, v11
    v_mul_f32 v29, 0x43800000, v11
    v_fract_f32 v11, v11
    v_fract_f32 v28, v28
    v_fract_f32 v29, v29
    v_exp_f32 v10, v10
    v_exp_f32 v26, v26
    v_exp_f32 v27, v27
    v_cos_f32 v20, v11
    v_sin_f32 v21, v11
    v_cos_f32 v22, v28
    v_sin_f32 v23, v28
    v_cos_f32 v24, v29
    v_sin_f32 v25, v29
    v_pk_mul_f32 v[30:31], v[14:15], v[12:13] op_sel:[0,0] op_sel_hi:[0,1]
    v_pk_fma_f32 v[30:31], v[14:15], v[12:13], v[30:31] op_sel:[1,1,0] op_sel_hi:[1,0,1] neg_lo:[1,0,0]
    v_pk_mul_f32 v[20:21], v[20:21], v[10:11] op_sel_hi:[1,0]
    v_pk_mul_f32 v[22:23], v[22:23], v[26:27] op_sel_hi:[1,0]
    v_pk_mul_f32 v[24:25], v[24:25], v[26:27] op_sel:[0,1] op_sel_hi:[1,1]
    v_mov_b32 v90, 0x00003f80
    ds_write_addtid_b32 v90 offset:11088
    v_cvt_pk_bf16_f32 v91, v30, -v31
    ds_write_addtid_b32 v91 offset:0
    v_cvt_pk_bf16_f32 v92, v22, v23
    ds_write_addtid_b32 v92 offset:11616
    v_pk_mul_f32 v[32:33], v[30:31], v[20:21] op_sel:[0,0] op_sel_hi:[0,1]
    v_pk_mul_f32 v[40:41], v[30:31], v[24:25] op_sel:[0,0] op_sel_hi:[0,1]
    v_pk_mul_f32 v[46:47], v[20:21], v[20:21] op_sel:[0,0] op_sel_hi:[0,1]
    v_pk_mul_f32 v[56:57], v[22:23], v[22:23] op_sel:[0,0] op_sel_hi:[0,1]
    v_pk_fma_f32 v[32:33], v[30:31], v[20:21], v[32:33] op_sel:[1,1,0] op_sel_hi:[1,0,1] neg_lo:[1,0,0]
    v_pk_fma_f32 v[40:41], v[30:31], v[24:25], v[40:41] op_sel:[1,1,0] op_sel_hi:[1,0,1] neg_lo:[1,0,0]
    v_pk_fma_f32 v[46:47], v[20:21], v[20:21], v[46:47] op_sel:[1,1,0] op_sel_hi:[1,0,1] neg_lo:[1,0,0]
    v_pk_fma_f32 v[56:57], v[22:23], v[22:23], v[56:57] op_sel:[1,1,0] op_sel_hi:[1,0,1] neg_lo:[1,0,0]
    v_cvt_pk_bf16_f32 v93, v32, -v33
    ds_write_addtid_b32 v93 offset:2112
    v_cvt_pk_bf16_f32 v94, v40, -v41
    ds_write_addtid_b32 v94 offset:1056
    v_cvt_pk_bf16_f32 v95, v56, v57
    ds_write_addtid_b32 v95 offset:12144
    v_pk_mul_f32 v[34:35], v[32:33], v[20:21] op_sel:[0,0] op_sel_hi:[0,1]
    v_pk_mul_f32 v[42:43], v[40:41], v[24:25] op_sel:[0,0] op_sel_hi:[0,1]
    v_pk_mul_f32 v[48:49], v[46:47], v[46:47] op_sel:[0,0] op_sel_hi:[0,1]
    v_pk_mul_f32 v[58:59], v[56:57], v[22:23] op_sel:[0,0] op_sel_hi:[0,1]
    v_pk_mul_f32 v[68:69], v[56:57], v[56:57] op_sel:[0,0] op_sel_hi:[0,1]
    v_pk_mul_f32 v[70:71], v[40:41], v[46:47] op_sel:[0,0] op_sel_hi:[0,1]
    v_pk_fma_f32 v[34:35], v[32:33], v[20:21], v[34:35] op_sel:[1,1,0] op_sel_hi:[1,0,1] neg_lo:[1,0,0]
    v_pk_fma_f32 v[42:43], v[40:41], v[24:25], v[42:43] op_sel:[1,1,0] op_sel_hi:[1,0,1] neg_lo:[1,0,0]
    v_pk_fma_f32 v[48:49], v[46:47], v[46:47], v[48:49] op_sel:[1,1,0] op_sel_hi:[1,0,1] neg_lo:[1,0,0]
    v_pk_fma_f32 v[58:59], v[56:57], v[22:23], v[58:59] op_sel:[1,1,0] op_sel_hi:[1,0,1] neg_lo:[1,0,0]
    v_pk_fma_f32 v[68:69], v[56:57], v[56:57], v[68:69] op_sel:[1,1,0] op_sel_hi:[1,0,1] neg_lo:[1,0,0]
    v_pk_fma_f32 v[70:71], v[40:41], v[46:47], v[70:71] op_sel:[1,1,0] op_sel_hi:[1,0,1] neg_lo:[1,0,0]
    v_cvt_pk_bf16_f32 v96, v34, -v35
    ds_write_addtid_b32 v96 offset:4224
    v_cvt_pk_bf16_f32 v97, v42, -v43
    ds_write_addtid_b32 v97 offset:8448
    v_cvt_pk_bf16_f32 v90, v58, v59
    ds_write_addtid_b32 v90 offset:12672
    v_cvt_pk_bf16_f32 v91, v68, v69
    ds_write_addtid_b32 v91 offset:13200
    v_cvt_pk_bf16_f32 v92, v70, -v71
    ds_write_addtid_b32 v92 offset:3168
    v_pk_mul_f32 v[32:33], v[34:35], v[20:21] op_sel:[0,0] op_sel_hi:[0,1]
    v_pk_mul_f32 v[44:45], v[42:43], v[24:25] op_sel:[0,0] op_sel_hi:[0,1]
    v_pk_mul_f32 v[50:51], v[46:47], v[48:49] op_sel:[0,0] op_sel_hi:[0,1]
    v_pk_mul_f32 v[62:63], v[22:23], v[68:69] op_sel:[0,0] op_sel_hi:[0,1]
    v_pk_mul_f32 v[64:65], v[56:57], v[68:69] op_sel:[0,0] op_sel_hi:[0,1]
    v_pk_mul_f32 v[66:67], v[58:59], v[68:69] op_sel:[0,0] op_sel_hi:[0,1]
    v_pk_mul_f32 v[70:71], v[40:41], v[48:49] op_sel:[0,0] op_sel_hi:[0,1]
    v_pk_mul_f32 v[72:73], v[42:43], v[48:49] op_sel:[0,0] op_sel_hi:[0,1]
    v_pk_fma_f32 v[32:33], v[34:35], v[20:21], v[32:33] op_sel:[1,1,0] op_sel_hi:[1,0,1] neg_lo:[1,0,0]
    v_pk_fma_f32 v[44:45], v[42:43], v[24:25], v[44:45] op_sel:[1,1,0] op_sel_hi:[1,0,1] neg_lo:[1,0,0]
    v_pk_fma_f32 v[50:51], v[46:47], v[48:49], v[50:51] op_sel:[1,1,0] op_sel_hi:[1,0,1] neg_lo:[1,0,0]
    v_pk_fma_f32 v[62:63], v[22:23], v[68:69], v[62:63] op_sel:[1,1,0] op_sel_hi:[1,0,1] neg_lo:[1,0,0]
    v_pk_fma_f32 v[64:65], v[56:57], v[68:69], v[64:65] op_sel:[1,1,0] op_sel_hi:[1,0,1] neg_lo:[1,0,0]
    v_pk_fma_f32 v[66:67], v[58:59], v[68:69], v[66:67] op_sel:[1,1,0] op_sel_hi:[1,0,1] neg_lo:[1,0,0]
    v_pk_fma_f32 v[70:71], v[40:41], v[48:49], v[70:71] op_sel:[1,1,0] op_sel_hi:[1,0,1] neg_lo:[1,0,0]
    v_pk_fma_f32 v[72:73], v[42:43], v[48:49], v[72:73] op_sel:[1,1,0] op_sel_hi:[1,0,1] neg_lo:[1,0,0]
    v_cvt_pk_bf16_f32 v93, v32, -v33
    ds_write_addtid_b32 v93 offset:6336
    v_cvt_pk_bf16_f32 v94, v44, -v45
    ds_write_addtid_b32 v94 offset:9504
    v_cvt_pk_bf16_f32 v95, v62, v63
    ds_write_addtid_b32 v95 offset:13728
    v_cvt_pk_bf16_f32 v96, v64, v65
    ds_write_addtid_b32 v96 offset:14256
    v_cvt_pk_bf16_f32 v97, v66, v67
    ds_write_addtid_b32 v97 offset:14784
    v_cvt_pk_bf16_f32 v90, v70, -v71
    ds_write_addtid_b32 v90 offset:5280
    v_cvt_pk_bf16_f32 v91, v72, -v73
    ds_write_addtid_b32 v91 offset:8976
    v_pk_mul_f32 v[34:35], v[32:33], v[20:21] op_sel:[0,0] op_sel_hi:[0,1]
    v_pk_mul_f32 v[36:37], v[44:45], v[24:25] op_sel:[0,0] op_sel_hi:[0,1]
    v_pk_mul_f32 v[70:71], v[40:41], v[50:51] op_sel:[0,0] op_sel_hi:[0,1]
    v_pk_mul_f32 v[72:73], v[44:45], v[48:49] op_sel:[0,0] op_sel_hi:[0,1]
    v_pk_mul_f32 v[52:53], v[68:69], v[68:69] op_sel:[0,0] op_sel_hi:[0,1]
    v_pk_mul_f32 v[54:55], v[62:63], v[68:69] op_sel:[0,0] op_sel_hi:[0,1]
    v_pk_mul_f32 v[56:57], v[64:65], v[68:69] op_sel:[0,0] op_sel_hi:[0,1]
    v_pk_mul_f32 v[58:59], v[66:67], v[68:69] op_sel:[0,0] op_sel_hi:[0,1]
    v_pk_fma_f32 v[34:35], v[32:33], v[20:21], v[34:35] op_sel:[1,1,0] op_sel_hi:[1,0,1] neg_lo:[1,0,0]
    v_pk_fma_f32 v[36:37], v[44:45], v[24:25], v[36:37] op_sel:[1,1,0] op_sel_hi:[1,0,1] neg_lo:[1,0,0]
    v_pk_fma_f32 v[70:71], v[40:41], v[50:51], v[70:71] op_sel:[1,1,0] op_sel_hi:[1,0,1] neg_lo:[1,0,0]
    v_pk_fma_f32 v[72:73], v[44:45], v[48:49], v[72:73] op_sel:[1,1,0] op_sel_hi:[1,0,1] neg_lo:[1,0,0]
    v_pk_fma_f32 v[52:53], v[68:69], v[68:69], v[52:53] op_sel:[1,1,0] op_sel_hi:[1,0,1] neg_lo:[1,0,0]
    v_pk_fma_f32 v[54:55], v[62:63], v[68:69], v[54:55] op_sel:[1,1,0] op_sel_hi:[1,0,1] neg_lo:[1,0,0]
    v_pk_fma_f32 v[56:57], v[64:65], v[68:69], v[56:57] op_sel:[1,1,0] op_sel_hi:[1,0,1] neg_lo:[1,0,0]
    v_pk_fma_f32 v[58:59], v[66:67], v[68:69], v[58:59] op_sel:[1,1,0] op_sel_hi:[1,0,1] neg_lo:[1,0,0]
    v_cvt_pk_bf16_f32 v92, v34, -v35
    ds_write_addtid_b32 v92 offset:528
    v_cvt_pk_bf16_f32 v93, v36, -v37
    ds_write_addtid_b32 v93 offset:10560
    v_cvt_pk_bf16_f32 v94, v70, -v71
    ds_write_addtid_b32 v94 offset:7392
    v_cvt_pk_bf16_f32 v95, v72, -v73
    ds_write_addtid_b32 v95 offset:10032
    v_cvt_pk_bf16_f32 v96, v52, v53
    ds_write_addtid_b32 v96 offset:15312
    v_cvt_pk_bf16_f32 v97, v54, v55
    ds_write_addtid_b32 v97 offset:15840
    v_cvt_pk_bf16_f32 v90, v56, v57
    ds_write_addtid_b32 v90 offset:16368
    v_cvt_pk_bf16_f32 v91, v58, v59
    ds_write_addtid_b32 v91 offset:16896
    v_pk_mul_f32 v[32:33], v[34:35], v[20:21] op_sel:[0,0] op_sel_hi:[0,1]
    v_pk_mul_f32 v[38:39], v[36:37], v[24:25] op_sel:[0,0] op_sel_hi:[0,1]
    v_pk_mul_f32 v[60:61], v[52:53], v[68:69] op_sel:[0,0] op_sel_hi:[0,1]
    v_pk_mul_f32 v[62:63], v[54:55], v[68:69] op_sel:[0,0] op_sel_hi:[0,1]
    v_pk_mul_f32 v[64:65], v[56:57], v[68:69] op_sel:[0,0] op_sel_hi:[0,1]
    v_pk_mul_f32 v[66:67], v[58:59], v[68:69] op_sel:[0,0] op_sel_hi:[0,1]
    v_pk_fma_f32 v[32:33], v[34:35], v[20:21], v[32:33] op_sel:[1,1,0] op_sel_hi:[1,0,1] neg_lo:[1,0,0]
    v_pk_fma_f32 v[38:39], v[36:37], v[24:25], v[38:39] op_sel:[1,1,0] op_sel_hi:[1,0,1] neg_lo:[1,0,0]
    v_pk_fma_f32 v[60:61], v[52:53], v[68:69], v[60:61] op_sel:[1,1,0] op_sel_hi:[1,0,1] neg_lo:[1,0,0]
    v_pk_fma_f32 v[62:63], v[54:55], v[68:69], v[62:63] op_sel:[1,1,0] op_sel_hi:[1,0,1] neg_lo:[1,0,0]
    v_pk_fma_f32 v[64:65], v[56:57], v[68:69], v[64:65] op_sel:[1,1,0] op_sel_hi:[1,0,1] neg_lo:[1,0,0]
    v_pk_fma_f32 v[66:67], v[58:59], v[68:69], v[66:67] op_sel:[1,1,0] op_sel_hi:[1,0,1] neg_lo:[1,0,0]
    v_cvt_pk_bf16_f32 v92, v32, -v33
    ds_write_addtid_b32 v92 offset:2640
    v_cvt_pk_bf16_f32 v93, v38, -v39
    ds_write_addtid_b32 v93 offset:1584
    v_cvt_pk_bf16_f32 v94, v60, v61
    ds_write_addtid_b32 v94 offset:17424
    v_cvt_pk_bf16_f32 v95, v62, v63
    ds_write_addtid_b32 v95 offset:17952
    v_cvt_pk_bf16_f32 v96, v64, v65
    ds_write_addtid_b32 v96 offset:18480
    v_cvt_pk_bf16_f32 v97, v66, v67
    ds_write_addtid_b32 v97 offset:19008
    v_pk_mul_f32 v[34:35], v[32:33], v[20:21] op_sel:[0,0] op_sel_hi:[0,1]
    v_pk_mul_f32 v[36:37], v[38:39], v[24:25] op_sel:[0,0] op_sel_hi:[0,1]
    v_pk_mul_f32 v[52:53], v[60:61], v[68:69] op_sel:[0,0] op_sel_hi:[0,1]
    v_pk_mul_f32 v[54:55], v[62:63], v[68:69] op_sel:[0,0] op_sel_hi:[0,1]
    v_pk_mul_f32 v[56:57], v[64:65], v[68:69] op_sel:[0,0] op_sel_hi:[0,1]
    v_pk_mul_f32 v[58:59], v[66:67], v[68:69] op_sel:[0,0] op_sel_hi:[0,1]
    v_pk_fma_f32 v[34:35], v[32:33], v[20:21], v[34:35] op_sel:[1,1,0] op_sel_hi:[1,0,1] neg_lo:[1,0,0]
    v_pk_fma_f32 v[36:37], v[38:39], v[24:25], v[36:37] op_sel:[1,1,0] op_sel_hi:[1,0,1] neg_lo:[1,0,0]
    v_pk_fma_f32 v[52:53], v[60:61], v[68:69], v[52:53] op_sel:[1,1,0] op_sel_hi:[1,0,1] neg_lo:[1,0,0]
    v_pk_fma_f32 v[54:55], v[62:63], v[68:69], v[54:55] op_sel:[1,1,0] op_sel_hi:[1,0,1] neg_lo:[1,0,0]
    v_pk_fma_f32 v[56:57], v[64:65], v[68:69], v[56:57] op_sel:[1,1,0] op_sel_hi:[1,0,1] neg_lo:[1,0,0]
    v_pk_fma_f32 v[58:59], v[66:67], v[68:69], v[58:59] op_sel:[1,1,0] op_sel_hi:[1,0,1] neg_lo:[1,0,0]
    v_cvt_pk_bf16_f32 v90, v34, -v35
    ds_write_addtid_b32 v90 offset:4752
    v_cvt_pk_bf16_f32 v91, v36, -v37
    ds_write_addtid_b32 v91 offset:3696
    v_cvt_pk_bf16_f32 v92, v52, v53
    ds_write_addtid_b32 v92 offset:19536
    v_cvt_pk_bf16_f32 v93, v54, v55
    ds_write_addtid_b32 v93 offset:20064
    v_cvt_pk_bf16_f32 v94, v56, v57
    ds_write_addtid_b32 v94 offset:20592
    v_cvt_pk_bf16_f32 v95, v58, v59
    ds_write_addtid_b32 v95 offset:21120
    v_pk_mul_f32 v[32:33], v[34:35], v[20:21] op_sel:[0,0] op_sel_hi:[0,1]
    v_pk_mul_f32 v[38:39], v[36:37], v[24:25] op_sel:[0,0] op_sel_hi:[0,1]
    v_pk_mul_f32 v[60:61], v[52:53], v[68:69] op_sel:[0,0] op_sel_hi:[0,1]
    v_pk_mul_f32 v[62:63], v[54:55], v[68:69] op_sel:[0,0] op_sel_hi:[0,1]
    v_pk_mul_f32 v[64:65], v[56:57], v[68:69] op_sel:[0,0] op_sel_hi:[0,1]
    v_pk_mul_f32 v[66:67], v[58:59], v[68:69] op_sel:[0,0] op_sel_hi:[0,1]
    v_pk_fma_f32 v[32:33], v[34:35], v[20:21], v[32:33] op_sel:[1,1,0] op_sel_hi:[1,0,1] neg_lo:[1,0,0]
    v_pk_fma_f32 v[38:39], v[36:37], v[24:25], v[38:39] op_sel:[1,1,0] op_sel_hi:[1,0,1] neg_lo:[1,0,0]
    v_pk_fma_f32 v[60:61], v[52:53], v[68:69], v[60:61] op_sel:[1,1,0] op_sel_hi:[1,0,1] neg_lo:[1,0,0]
    v_pk_fma_f32 v[62:63], v[54:55], v[68:69], v[62:63] op_sel:[1,1,0] op_sel_hi:[1,0,1] neg_lo:[1,0,0]
    v_pk_fma_f32 v[64:65], v[56:57], v[68:69], v[64:65] op_sel:[1,1,0] op_sel_hi:[1,0,1] neg_lo:[1,0,0]
    v_pk_fma_f32 v[66:67], v[58:59], v[68:69], v[66:67] op_sel:[1,1,0] op_sel_hi:[1,0,1] neg_lo:[1,0,0]
    v_cvt_pk_bf16_f32 v96, v32, -v33
    ds_write_addtid_b32 v96 offset:6864
    v_cvt_pk_bf16_f32 v97, v38, -v39
    ds_write_addtid_b32 v97 offset:5808
    v_cvt_pk_bf16_f32 v90, v60, v61
    ds_write_addtid_b32 v90 offset:21648
    v_cvt_pk_bf16_f32 v91, v62, v63
    ds_write_addtid_b32 v91 offset:22176
    v_cvt_pk_bf16_f32 v92, v64, v65
    ds_write_addtid_b32 v92 offset:22704
    v_cvt_pk_bf16_f32 v93, v66, v67
    ds_write_addtid_b32 v93 offset:23232
    v_pk_mul_f32 v[36:37], v[38:39], v[24:25] op_sel:[0,0] op_sel_hi:[0,1]
    v_pk_mul_f32 v[52:53], v[60:61], v[68:69] op_sel:[0,0] op_sel_hi:[0,1]
    v_pk_mul_f32 v[54:55], v[62:63], v[68:69] op_sel:[0,0] op_sel_hi:[0,1]
    v_pk_mul_f32 v[56:57], v[64:65], v[68:69] op_sel:[0,0] op_sel_hi:[0,1]
    v_pk_mul_f32 v[58:59], v[66:67], v[68:69] op_sel:[0,0] op_sel_hi:[0,1]
    v_pk_fma_f32 v[36:37], v[38:39], v[24:25], v[36:37] op_sel:[1,1,0] op_sel_hi:[1,0,1] neg_lo:[1,0,0]
    v_pk_fma_f32 v[52:53], v[60:61], v[68:69], v[52:53] op_sel:[1,1,0] op_sel_hi:[1,0,1] neg_lo:[1,0,0]
    v_pk_fma_f32 v[54:55], v[62:63], v[68:69], v[54:55] op_sel:[1,1,0] op_sel_hi:[1,0,1] neg_lo:[1,0,0]
    v_pk_fma_f32 v[56:57], v[64:65], v[68:69], v[56:57] op_sel:[1,1,0] op_sel_hi:[1,0,1] neg_lo:[1,0,0]
    v_pk_fma_f32 v[58:59], v[66:67], v[68:69], v[58:59] op_sel:[1,1,0] op_sel_hi:[1,0,1] neg_lo:[1,0,0]
    v_cvt_pk_bf16_f32 v94, v36, -v37
    ds_write_addtid_b32 v94 offset:7920
    v_cvt_pk_bf16_f32 v95, v52, v53
    ds_write_addtid_b32 v95 offset:23760
    v_cvt_pk_bf16_f32 v96, v54, v55
    ds_write_addtid_b32 v96 offset:24288
    v_cvt_pk_bf16_f32 v97, v56, v57
    ds_write_addtid_b32 v97 offset:24816
    v_cvt_pk_bf16_f32 v90, v58, v59
    ds_write_addtid_b32 v90 offset:25344
    v_pk_mul_f32 v[60:61], v[52:53], v[68:69] op_sel:[0,0] op_sel_hi:[0,1]
    v_pk_mul_f32 v[62:63], v[54:55], v[68:69] op_sel:[0,0] op_sel_hi:[0,1]
    v_pk_mul_f32 v[64:65], v[56:57], v[68:69] op_sel:[0,0] op_sel_hi:[0,1]
    v_pk_mul_f32 v[66:67], v[58:59], v[68:69] op_sel:[0,0] op_sel_hi:[0,1]
    v_pk_fma_f32 v[60:61], v[52:53], v[68:69], v[60:61] op_sel:[1,1,0] op_sel_hi:[1,0,1] neg_lo:[1,0,0]
    v_pk_fma_f32 v[62:63], v[54:55], v[68:69], v[62:63] op_sel:[1,1,0] op_sel_hi:[1,0,1] neg_lo:[1,0,0]
    v_pk_fma_f32 v[64:65], v[56:57], v[68:69], v[64:65] op_sel:[1,1,0] op_sel_hi:[1,0,1] neg_lo:[1,0,0]
    v_pk_fma_f32 v[66:67], v[58:59], v[68:69], v[66:67] op_sel:[1,1,0] op_sel_hi:[1,0,1] neg_lo:[1,0,0]
    v_cvt_pk_bf16_f32 v91, v60, v61
    ds_write_addtid_b32 v91 offset:25872
    v_cvt_pk_bf16_f32 v92, v62, v63
    ds_write_addtid_b32 v92 offset:26400
    v_cvt_pk_bf16_f32 v93, v64, v65
    ds_write_addtid_b32 v93 offset:26928
    v_cvt_pk_bf16_f32 v94, v66, v67
    ds_write_addtid_b32 v94 offset:27456
    v_lshrrev_b32 v4, 4, v1
    v_and_b32 v5, 15, v1
    v_lshrrev_b32 v6, 2, v5
    v_and_b32 v7, 3, v1
    s_waitcnt vmcnt(0) lgkmcnt(0)
    s_barrier
    v_mov_b32 v2, 0
    buffer_load_dword v119, v2, s[84:87], 0 offen sc1
    s_cmp_ge_u32 s2, 128
    s_cbranch_scc1 L_proc_w
    v_mov_b32 v12, 0
    v_mov_b32 v13, 0
    v_mov_b32 v14, 0
    v_mov_b32 v15, 0
    s_mul_i32 s18, s2, 384
    s_add_u32 s18, s18, 23789568
    v_lshlrev_b32 v2, 4, v0
    v_cmp_gt_u32 vcc, 24, v0
    s_nop 1
    s_and_saveexec_b64 s[36:37], vcc
    s_cbranch_execz L_z_2
    buffer_store_dwordx4 v[12:15], v2, s[8:11], s18 offen sc1
L_z_2:
    s_mov_b64 exec, s[36:37]
    v_lshrrev_b32 v11, 1, v7
    v_lshl_add_u32 v11, v4, 1, v11
    v_lshl_add_u32 v11, v11, 3, v6
    v_lshlrev_b32 v11, 8, v11
    v_xor_b32 v12, s33, v6
    v_lshl_add_u32 v11, v12, 6, v11
    v_and_b32 v12, 1, v7
    v_lshl_add_u32 v11, v12, 3, v11
    v_add_u32 v11, 66560, v11
    ds_read_b64_tr_b16 v[60:61], v11 offset:0
    ds_read_b64_tr_b16 v[62:63], v11 offset:1024
    ds_read_b64_tr_b16 v[64:65], v11 offset:16
    ds_read_b64_tr_b16 v[66:67], v11 offset:1040
    ds_read_b64_tr_b16 v[68:69], v11 offset:32
    ds_read_b64_tr_b16 v[70:71], v11 offset:1056
    ds_read_b64_tr_b16 v[72:73], v11 offset:48
    ds_read_b64_tr_b16 v[74:75], v11 offset:1072
    v_and_b32 v12, 7, v1
    v_lshlrev_b32 v12, 6, v12
    v_bfe_u32 v13, v1, 3, 2
    v_lshl_add_u32 v12, v13, 4, v12
    v_lshrrev_b32 v13, 5, v1
    v_lshl_add_u32 v12, v13, 15, v12
    s_lshl_b32 s18, s30, 13
    s_lshl_b32 s19, s33, 11
    s_add_u32 s18, s18, s19
    s_lshl_b32 s19, s29, 16
    s_add_u32 s18, s18, s19
    s_add_u32 s18, s18, 0
    v_mov_b32 v40, 0
    v_mov_b32 v41, 0
    v_mov_b32 v42, 0
    v_mov_b32 v43, 0
    v_mov_b32 v44, 0
    v_mov_b32 v45, 0
    v_mov_b32 v46, 0
    v_mov_b32 v47, 0
    v_dot2c_f32_bf16 v40, 0x3f803f80, v120
    v_dot2c_f32_bf16 v41, v120, v120
    v_dot2c_f32_bf16 v40, 0x3f803f80, v121
    v_dot2c_f32_bf16 v41, v121, v121
    v_dot2c_f32_bf16 v40, 0x3f803f80, v122
    v_dot2c_f32_bf16 v41, v122, v122
    v_dot2c_f32_bf16 v40, 0x3f803f80, v123
    v_dot2c_f32_bf16 v41, v123, v123
    v_dot2c_f32_bf16 v42, 0x3f803f80, v124
    v_dot2c_f32_bf16 v43, v124, v124
    v_dot2c_f32_bf16 v42, 0x3f803f80, v125
    v_dot2c_f32_bf16 v43, v125, v125
    v_dot2c_f32_bf16 v42, 0x3f803f80, v126
    v_dot2c_f32_bf16 v43, v126, v126
    v_dot2c_f32_bf16 v42, 0x3f803f80, v127
    v_dot2c_f32_bf16 v43, v127, v127
    v_dot2c_f32_bf16 v44, 0x3f803f80, v128
    v_dot2c_f32_bf16 v45, v128, v128
    v_dot2c_f32_bf16 v44, 0x3f803f80, v129
    v_dot2c_f32_bf16 v45, v129, v129
    v_dot2c_f32_bf16 v44, 0x3f803f80, v130
    v_dot2c_f32_bf16 v45, v130, v130
    v_dot2c_f32_bf16 v44, 0x3f803f80, v131
    v_dot2c_f32_bf16 v45, v131, v131
    v_dot2c_f32_bf16 v46, 0x3f803f80, v132
    v_dot2c_f32_bf16 v47, v132, v132
    v_dot2c_f32_bf16 v46, 0x3f803f80, v133
    v_dot2c_f32_bf16 v47, v133, v133
    v_dot2c_f32_bf16 v46, 0x3f803f80, v134
    v_dot2c_f32_bf16 v47, v134, v134
    v_dot2c_f32_bf16 v46, 0x3f803f80, v135
    v_dot2c_f32_bf16 v47, v135, v135
    s_waitcnt lgkmcnt(0)
    buffer_store_dwordx4 v[60:63], v12, s[8:11], s18 offen offset:0 sc1
    buffer_store_dwordx4 v[64:67], v12, s[8:11], s18 offen offset:512 sc1
    buffer_store_dwordx4 v[68:71], v12, s[8:11], s18 offen offset:1024 sc1
    buffer_store_dwordx4 v[72:75], v12, s[8:11], s18 offen offset:1536 sc1
    v_permlane32_swap_b32 v40, v41
    v_permlane32_swap_b32 v42, v43
    v_permlane32_swap_b32 v44, v45
    v_permlane32_swap_b32 v46, v47
    v_add_f32 v40, v40, v41
    v_add_f32 v42, v42, v43
    v_add_f32 v44, v44, v45
    v_add_f32 v46, v46, v47
    v_permlane16_swap_b32 v40, v42
    s_nop 0
    v_permlane16_swap_b32 v44, v46
    v_add_f32 v40, v40, v42
    v_add_f32 v44, v44, v46
    s_nop 0
    v_add_f32_dpp v40, v40, v40 row_ror:8 row_mask:0xf bank_mask:0xf
    v_add_f32_dpp v44, v44, v44 row_ror:8 row_mask:0xf bank_mask:0xf
    s_nop 0
    v_add_f32_dpp v40, v40, v40 row_ror:4 row_mask:0xf bank_mask:0xf
    v_add_f32_dpp v44, v44, v44 row_ror:4 row_mask:0xf bank_mask:0xf
    s_nop 0
    v_add_f32_dpp v40, v40, v40 row_ror:2 row_mask:0xf bank_mask:0xf
    v_add_f32_dpp v44, v44, v44 row_ror:2 row_mask:0xf bank_mask:0xf
    s_nop 0
    v_add_f32_dpp v40, v40, v40 row_ror:1 row_mask:0xf bank_mask:0xf
    v_add_f32_dpp v44, v44, v44 row_ror:1 row_mask:0xf bank_mask:0xf
    v_and_b32 v13, 1, v4
    v_lshlrev_b32 v13, 2, v13
    v_lshrrev_b32 v14, 1, v4
    v_lshl_add_u32 v13, v14, 6, v13
    s_lshl_b32 s18, s33, 4
    s_add_u32 s18, s18, 99328
    v_add_u32 v13, s18, v13
    ds_write_b32 v13, v40
    ds_write_b32 v13, v44 offset:8
    v_lshlrev_b32 v13, 2, v1
    v_add_u32 v13, 99328, v13
    v_and_b32 v14, 1, v4
    v_lshlrev_b32 v14, 13, v14
    v_lshl_add_u32 v14, v5, 2, v14
    s_lshl_b32 s18, s2, 6
    s_add_u32 s18, s18, 23724032
    s_waitcnt lgkmcnt(0)
    s_barrier
    s_cmp_lg_u32 s33, 0
    s_cbranch_scc1 L_proc_done
    ds_read_b32 v40, v13
    s_mov_b32 exec_hi, 0
    s_waitcnt lgkmcnt(0)
    buffer_store_dword v40, v14, s[8:11], s18 offen sc1
    s_mov_b64 exec, -1
    s_branch L_proc_done
L_proc_w:
    s_cmp_ge_u32 s2, 192
    s_cbranch_scc1 L_proc_w2
    v_lshl_add_u32 v11, v4, 3, v6
    v_lshlrev_b32 v11, 10, v11
    v_lshl_add_u32 v11, v7, 3, v11
    v_add_u32 v11, 66560, v11
    s_mul_i32 s31, s33, 7
    s_mul_i32 s18, s30, 28
    s_add_u32 s32, s18, s31
    s_add_u32 s18, s31, 0
    s_xor_b32 s18, s18, 0
    v_xor_b32 v12, s18, v6
    v_lshl_add_u32 v12, v12, 5, v11
    ds_read_b64_tr_b16 v[48:49], v12 offset:0
    s_add_u32 s18, s31, 0
    s_xor_b32 s18, s18, 4
    v_xor_b32 v12, s18, v6
    v_lshl_add_u32 v12, v12, 5, v11
    ds_read_b64_tr_b16 v[50:51], v12 offset:4096
    s_add_u32 s18, s31, 1
    s_xor_b32 s18, s18, 0
    v_xor_b32 v12, s18, v6
    v_lshl_add_u32 v12, v12, 5, v11
    ds_read_b64_tr_b16 v[52:53], v12 offset:0
    s_add_u32 s18, s31, 1
    s_xor_b32 s18, s18, 4
    v_xor_b32 v12, s18, v6
    v_lshl_add_u32 v12, v12, 5, v11
    ds_read_b64_tr_b16 v[54:55], v12 offset:4096
    s_add_u32 s18, s31, 2
    s_xor_b32 s18, s18, 0
    v_xor_b32 v12, s18, v6
    v_lshl_add_u32 v12, v12, 5, v11
    ds_read_b64_tr_b16 v[56:57], v12 offset:0
    s_add_u32 s18, s31, 2
    s_xor_b32 s18, s18, 4
    v_xor_b32 v12, s18, v6
    v_lshl_add_u32 v12, v12, 5, v11
    ds_read_b64_tr_b16 v[58:59], v12 offset:4096
    s_add_u32 s18, s31, 3
    s_xor_b32 s18, s18, 0
    v_xor_b32 v12, s18, v6
    v_lshl_add_u32 v12, v12, 5, v11
    ds_read_b64_tr_b16 v[60:61], v12 offset:0
    s_add_u32 s18, s31, 3
    s_xor_b32 s18, s18, 4
    v_xor_b32 v12, s18, v6
    v_lshl_add_u32 v12, v12, 5, v11
    ds_read_b64_tr_b16 v[62:63], v12 offset:4096
    s_add_u32 s18, s31, 4
    s_xor_b32 s18, s18, 0
    v_xor_b32 v12, s18, v6
    v_lshl_add_u32 v12, v12, 5, v11
    ds_read_b64_tr_b16 v[64:65], v12 offset:0
    s_add_u32 s18, s31, 4
    s_xor_b32 s18, s18, 4
    v_xor_b32 v12, s18, v6
    v_lshl_add_u32 v12, v12, 5, v11
    ds_read_b64_tr_b16 v[66:67], v12 offset:4096
    s_add_u32 s18, s31, 5
    s_xor_b32 s18, s18, 0
    v_xor_b32 v12, s18, v6
    v_lshl_add_u32 v12, v12, 5, v11
    ds_read_b64_tr_b16 v[68:69], v12 offset:0
    s_add_u32 s18, s31, 5
    s_xor_b32 s18, s18, 4
    v_xor_b32 v12, s18, v6
    v_lshl_add_u32 v12, v12, 5, v11
    ds_read_b64_tr_b16 v[70:71], v12 offset:4096
    s_add_u32 s18, s31, 6
    s_xor_b32 s18, s18, 0
    v_xor_b32 v12, s18, v6
    v_lshl_add_u32 v12, v12, 5, v11
    ds_read_b64_tr_b16 v[72:73], v12 offset:0
    s_add_u32 s18, s31, 6
    s_xor_b32 s18, s18, 4
    v_xor_b32 v12, s18, v6
    v_lshl_add_u32 v12, v12, 5, v11
    ds_read_b64_tr_b16 v[74:75], v12 offset:4096
    s_lshl_b32 s19, s29, 11
    s_add_u32 s19, s19, 15728640
    s_add_u32 s18, s32, 0
    s_and_b32 s31, s18, 1
    s_lshl_b32 s31, s31, 10
    s_lshr_b32 s18, s18, 1
    s_lshl_b32 s18, s18, 15
    s_add_u32 s18, s18, s31
    s_add_u32 s18, s18, s19
    s_waitcnt lgkmcnt(12)
    buffer_store_dwordx4 v[48:51], v8, s[8:11], s18 offen sc1
    s_add_u32 s18, s32, 1
    s_and_b32 s31, s18, 1
    s_lshl_b32 s31, s31, 10
    s_lshr_b32 s18, s18, 1
    s_lshl_b32 s18, s18, 15
    s_add_u32 s18, s18, s31
    s_add_u32 s18, s18, s19
    s_waitcnt lgkmcnt(10)
    buffer_store_dwordx4 v[52:55], v8, s[8:11], s18 offen sc1
    s_add_u32 s18, s32, 2
    s_and_b32 s31, s18, 1
    s_lshl_b32 s31, s31, 10
    s_lshr_b32 s18, s18, 1
    s_lshl_b32 s18, s18, 15
    s_add_u32 s18, s18, s31
    s_add_u32 s18, s18, s19
    s_waitcnt lgkmcnt(8)
    buffer_store_dwordx4 v[56:59], v8, s[8:11], s18 offen sc1
    s_add_u32 s18, s32, 3
    s_and_b32 s31, s18, 1
    s_lshl_b32 s31, s31, 10
    s_lshr_b32 s18, s18, 1
    s_lshl_b32 s18, s18, 15
    s_add_u32 s18, s18, s31
    s_add_u32 s18, s18, s19
    s_waitcnt lgkmcnt(6)
    buffer_store_dwordx4 v[60:63], v8, s[8:11], s18 offen sc1
    s_add_u32 s18, s32, 4
    s_and_b32 s31, s18, 1
    s_lshl_b32 s31, s31, 10
    s_lshr_b32 s18, s18, 1
    s_lshl_b32 s18, s18, 15
    s_add_u32 s18, s18, s31
    s_add_u32 s18, s18, s19
    s_waitcnt lgkmcnt(4)
    buffer_store_dwordx4 v[64:67], v8, s[8:11], s18 offen sc1
    s_add_u32 s18, s32, 5
    s_and_b32 s31, s18, 1
    s_lshl_b32 s31, s31, 10
    s_lshr_b32 s18, s18, 1
    s_lshl_b32 s18, s18, 15
    s_add_u32 s18, s18, s31
    s_add_u32 s18, s18, s19
    s_waitcnt lgkmcnt(2)
    buffer_store_dwordx4 v[68:71], v8, s[8:11], s18 offen sc1
    s_add_u32 s18, s32, 6
    s_and_b32 s31, s18, 1
    s_lshl_b32 s31, s31, 10
    s_lshr_b32 s18, s18, 1
    s_lshl_b32 s18, s18, 15
    s_add_u32 s18, s18, s31
    s_add_u32 s18, s18, s19
    s_waitcnt lgkmcnt(0)
    buffer_store_dwordx4 v[72:75], v8, s[8:11], s18 offen sc1
    s_branch L_proc_done
L_proc_w2:
    s_cmp_ge_u32 s2, 248
    s_cbranch_scc1 L_proc_done
    v_lshl_add_u32 v12, v4, 2, v6
    v_lshlrev_b32 v11, 10, v12
    v_lshl_add_u32 v11, v7, 3, v11
    v_and_b32 v12, 7, v12
    v_lshl_add_u32 v11, v12, 5, v11
    s_lshl_b32 s18, s33, 8
    s_add_u32 s18, s18, 66560
    v_add_u32 v11, s18, v11
    s_mul_i32 s18, s33, 458752
    s_lshl_b32 s19, s29, 12
    s_add_u32 s18, s18, s19
    s_add_u32 s18, s18, 17563648
    s_add_u32 s19, s18, 229376
    v_xor_b32 v12, 0, v11
    ds_read_b64_tr_b16 v[48:49], v12 offset:0
    ds_read_b64_tr_b16 v[50:51], v12 offset:16384
    v_xor_b32 v12, 32, v11
    ds_read_b64_tr_b16 v[52:53], v12 offset:0
    ds_read_b64_tr_b16 v[54:55], v12 offset:16384
    v_xor_b32 v12, 64, v11
    ds_read_b64_tr_b16 v[56:57], v12 offset:0
    ds_read_b64_tr_b16 v[58:59], v12 offset:16384
    v_xor_b32 v12, 96, v11
    ds_read_b64_tr_b16 v[60:61], v12 offset:0
    ds_read_b64_tr_b16 v[62:63], v12 offset:16384
    v_xor_b32 v12, 128, v11
    ds_read_b64_tr_b16 v[64:65], v12 offset:0
    ds_read_b64_tr_b16 v[66:67], v12 offset:16384
    v_xor_b32 v12, 160, v11
    ds_read_b64_tr_b16 v[68:69], v12 offset:0
    ds_read_b64_tr_b16 v[70:71], v12 offset:16384
    v_xor_b32 v12, 192, v11
    ds_read_b64_tr_b16 v[72:73], v12 offset:0
    ds_read_b64_tr_b16 v[74:75], v12 offset:16384
    v_xor_b32 v12, 224, v11
    ds_read_b64_tr_b16 v[76:77], v12 offset:0
    ds_read_b64_tr_b16 v[78:79], v12 offset:16384
    s_waitcnt lgkmcnt(14)
    buffer_store_dwordx4 v[48:51], v8, s[8:11], s18 offen offset:0 sc1
    s_waitcnt lgkmcnt(12)
    buffer_store_dwordx4 v[52:55], v8, s[8:11], s18 offen offset:1024 sc1
    s_waitcnt lgkmcnt(10)
    buffer_store_dwordx4 v[56:59], v8, s[8:11], s18 offen offset:2048 sc1
    s_waitcnt lgkmcnt(8)
    buffer_store_dwordx4 v[60:63], v8, s[8:11], s18 offen offset:3072 sc1
    s_waitcnt lgkmcnt(6)
    buffer_store_dwordx4 v[64:67], v8, s[8:11], s19 offen offset:0 sc1
    s_waitcnt lgkmcnt(4)
    buffer_store_dwordx4 v[68:71], v8, s[8:11], s19 offen offset:1024 sc1
    s_waitcnt lgkmcnt(2)
    buffer_store_dwordx4 v[72:75], v8, s[8:11], s19 offen offset:2048 sc1
    s_waitcnt lgkmcnt(0)
    buffer_store_dwordx4 v[76:79], v8, s[8:11], s19 offen offset:3072 sc1
L_proc_done:
    v_and_b32 v3, 15, v1
    v_lshrrev_b32 v5, 4, v1
    s_mul_i32 s18, s25, 27984
    v_lshl_add_u32 v7, v5, 4, s18
    v_lshrrev_b32 v10, 2, v3
    v_lshlrev_b32 v10, 1, v10
    v_and_b32 v11, 1, v3
    v_add_u32 v10, v10, v11
    v_min_u32 v10, 4, v10
    v_add_u32 v10, 16, v10
    v_mul_u32_u24 v10, 528, v10
    v_add_u32 v10, v10, v7
    s_lshl_b32 s18, s28, 4
    v_add_u32 v11, s18, v3
    v_mul_u32_u24 v12, 528, v11
    v_add_u32 v12, v12, v7
    v_mul_u32_u24 v13, 528, v3
    v_add_u32 v13, v13, v7
    s_mul_i32 s18, s25, 4640
    s_add_u32 s18, s18, 102432
    v_lshl_add_u32 v14, v11, 4, s18
    v_lshl_add_u32 v15, v5, 1, v14
    v_lshl_add_u32 v16, v5, 2, v14
    v_lshl_add_u32 v17, v5, 9, v14
    ds_read_b128 v[28:31], v13 offset:0
    ds_read_b128 v[32:35], v12 offset:11088
    ds_read_b128 v[36:39], v10 offset:0
    ds_read_b128 v[40:43], v13 offset:64
    ds_read_b128 v[44:47], v12 offset:11152
    ds_read_b128 v[48:51], v10 offset:64
    ds_read_b128 v[52:55], v13 offset:128
    ds_read_b128 v[56:59], v12 offset:11216
    ds_read_b128 v[60:63], v10 offset:128
    ds_read_b128 v[64:67], v13 offset:192
    ds_read_b128 v[68:71], v12 offset:11280
    ds_read_b128 v[72:75], v10 offset:192
    ds_read_b128 v[76:79], v13 offset:256
    ds_read_b128 v[80:83], v12 offset:11344
    ds_read_b128 v[84:87], v10 offset:256
    s_waitcnt lgkmcnt(12)
    v_mfma_f32_16x16x32_bf16 v[20:23], v[28:31], v[32:35], 0
    v_mfma_f32_16x16x32_bf16 v[24:27], v[36:39], v[32:35], 0
    ds_read_b128 v[28:31], v13 offset:320
    ds_read_b128 v[32:35], v12 offset:11408
    ds_read_b128 v[36:39], v10 offset:320
    s_waitcnt lgkmcnt(12)
    v_mfma_f32_16x16x32_bf16 v[20:23], v[40:43], v[44:47], v[20:23]
    v_mfma_f32_16x16x32_bf16 v[24:27], v[48:51], v[44:47], v[24:27]
    ds_read_b128 v[40:43], v13 offset:384
    ds_read_b128 v[44:47], v12 offset:11472
    ds_read_b128 v[48:51], v10 offset:384
    s_waitcnt lgkmcnt(12)
    v_mfma_f32_16x16x32_bf16 v[20:23], v[52:55], v[56:59], v[20:23]
    v_mfma_f32_16x16x32_bf16 v[24:27], v[60:63], v[56:59], v[24:27]
    ds_read_b128 v[52:55], v13 offset:448
    ds_read_b128 v[56:59], v12 offset:11536
    ds_read_b128 v[60:63], v10 offset:448
    s_waitcnt lgkmcnt(12)
    v_mfma_f32_16x16x32_bf16 v[20:23], v[64:67], v[68:71], v[20:23]
    v_mfma_f32_16x16x32_bf16 v[24:27], v[72:75], v[68:71], v[24:27]
    s_waitcnt lgkmcnt(9)
    v_mfma_f32_16x16x32_bf16 v[20:23], v[76:79], v[80:83], v[20:23]
    v_mfma_f32_16x16x32_bf16 v[24:27], v[84:87], v[80:83], v[24:27]
    s_waitcnt lgkmcnt(6)
    v_mfma_f32_16x16x32_bf16 v[20:23], v[28:31], v[32:35], v[20:23]
    v_mfma_f32_16x16x32_bf16 v[24:27], v[36:39], v[32:35], v[24:27]
    s_waitcnt lgkmcnt(3)
    v_mfma_f32_16x16x32_bf16 v[20:23], v[40:43], v[44:47], v[20:23]
    v_mfma_f32_16x16x32_bf16 v[24:27], v[48:51], v[44:47], v[24:27]
    s_waitcnt lgkmcnt(0)
    v_mfma_f32_16x16x32_bf16 v[20:23], v[52:55], v[56:59], v[20:23]
    v_mfma_f32_16x16x32_bf16 v[24:27], v[60:63], v[56:59], v[24:27]
    s_nop 6
    v_cvt_pk_bf16_f32 v28, v20, v21
    v_cvt_pk_bf16_f32 v29, v22, v23
    v_cvt_pk_bf16_f32 v30, v24, v25
    ds_write_b16 v15, v28 offset:0
    ds_write_b16_d16_hi v15, v28 offset:8
    ds_write_b16 v16, v29 offset:512
    ds_write_b16_d16_hi v17, v29 offset:2560
    s_mov_b32 exec_hi, 0xffff
    ds_write_b16 v17, v30 offset:1024
    s_mov_b32 exec_hi, 0
    ds_write_b16_d16_hi v17, v30 offset:1032
    s_mov_b64 exec, -1
    s_waitcnt lgkmcnt(0)
    s_waitcnt vmcnt(0)
    s_barrier
    s_mov_b32 s18, 200000
    v_mov_b32 v2, 0
L_pa_6:
    v_cmp_ne_u32 vcc, 0, v119
    s_nop 1
    s_cmp_eq_u64 vcc, -1
    s_cbranch_scc1 L_pa_7
    s_sleep 4
    buffer_load_dword v119, v2, s[84:87], 0 offen sc1
    s_waitcnt vmcnt(0)
    s_sub_u32 s18, s18, 1
    s_cmp_lg_u32 s18, 0
    s_cbranch_scc1 L_pa_6
L_pa_7:
    s_cmp_lg_u32 s33, 0
    s_cbranch_scc1 L_pa_5
    s_lshr_b32 s18, s2, 7
    s_lshl_b32 s18, s18, 15
    s_add_u32 s18, s18, s27
    s_add_u32 s18, s18, 31719424
    v_mov_b32 v3, 1
    s_mov_b64 exec, 1
    buffer_atomic_add v3, v2, s[8:11], s18 offen sc1
    s_mov_b64 exec, -1
L_pa_5:
    ds_read_u16 v20, v100 offset:0
    ds_read_u16 v21, v101 offset:0
    ds_read_u16 v22, v102 offset:0
    ds_read_u16 v23, v103 offset:0
    ds_read_u16 v24, v104 offset:0
    ds_read_u16 v25, v105 offset:0
    ds_read_u16 v26, v106 offset:0
    ds_read_u16 v27, v107 offset:0
    ds_read_u16 v28, v108 offset:0
    ds_read_u16 v29, v109 offset:0
    ds_read_u16 v30, v110 offset:0
    ds_read_u16 v31, v111 offset:0
    ds_read_u16 v32, v112 offset:0
    ds_read_u16 v33, v113 offset:0
    ds_read_u16 v34, v114 offset:0
    ds_read_u16 v36, v100 offset:4640
    ds_read_u16 v37, v101 offset:4640
    ds_read_u16 v38, v102 offset:4640
    ds_read_u16 v39, v103 offset:4640
    ds_read_u16 v40, v104 offset:4640
    ds_read_u16 v41, v105 offset:4640
    ds_read_u16 v42, v106 offset:4640
    ds_read_u16 v43, v107 offset:4640
    ds_read_u16 v44, v108 offset:4640
    ds_read_u16 v45, v109 offset:4640
    ds_read_u16 v46, v110 offset:4640
    ds_read_u16 v47, v111 offset:4640
    ds_read_u16 v48, v112 offset:4640
    ds_read_u16 v49, v113 offset:4640
    ds_read_u16 v50, v114 offset:4640
    v_lshlrev_b32 v3, 4, v0
    s_waitcnt lgkmcnt(15)
    v_lshl_or_b32 v52, v21, 16, v20
    v_lshl_or_b32 v53, v23, 16, v22
    v_lshl_or_b32 v54, v25, 16, v24
    v_lshl_or_b32 v55, v27, 16, v26
    v_lshl_or_b32 v56, v29, 16, v28
    v_lshl_or_b32 v57, v31, 16, v30
    v_lshl_or_b32 v60, v23, 16, v22
    v_lshl_or_b32 v61, v25, 16, v24
    v_lshl_or_b32 v62, v27, 16, v26
    v_lshl_or_b32 v63, v29, 16, v28
    v_lshl_or_b32 v64, v31, 16, v30
    v_lshl_or_b32 v65, v33, 16, v32
    ds_write_b128 v3, v[52:55] offset:29120
    ds_write_b128 v3, v[60:63] offset:20800
    ds_write_b128 v3, v[54:57] offset:12480
    ds_write_b128 v3, v[62:65] offset:4160
    v_lshl_or_b32 v68, v22, 16, v21
    v_lshl_or_b32 v69, v24, 16, v23
    v_lshl_or_b32 v70, v26, 16, v25
    v_lshl_or_b32 v71, v28, 16, v27
    v_lshl_or_b32 v72, v30, 16, v29
    v_lshl_or_b32 v73, v32, 16, v31
    v_lshl_or_b32 v76, v24, 16, v23
    v_lshl_or_b32 v77, v26, 16, v25
    v_lshl_or_b32 v78, v28, 16, v27
    v_lshl_or_b32 v79, v30, 16, v29
    v_lshl_or_b32 v80, v32, 16, v31
    v_lshl_or_b32 v81, v34, 16, v33
    ds_write_b128 v3, v[68:71] offset:24960
    ds_write_b128 v3, v[76:79] offset:16640
    ds_write_b128 v3, v[70:73] offset:8320
    ds_write_b128 v3, v[78:81] offset:0
    s_waitcnt lgkmcnt(8)
    v_lshl_or_b32 v52, v37, 16, v36
    v_lshl_or_b32 v53, v39, 16, v38
    v_lshl_or_b32 v54, v41, 16, v40
    v_lshl_or_b32 v55, v43, 16, v42
    v_lshl_or_b32 v56, v45, 16, v44
    v_lshl_or_b32 v57, v47, 16, v46
    v_lshl_or_b32 v60, v39, 16, v38
    v_lshl_or_b32 v61, v41, 16, v40
    v_lshl_or_b32 v62, v43, 16, v42
    v_lshl_or_b32 v63, v45, 16, v44
    v_lshl_or_b32 v64, v47, 16, v46
    v_lshl_or_b32 v65, v49, 16, v48
    ds_write_b128 v3, v[52:55] offset:62400
    ds_write_b128 v3, v[60:63] offset:54080
    ds_write_b128 v3, v[54:57] offset:45760
    ds_write_b128 v3, v[62:65] offset:37440
    v_lshl_or_b32 v68, v38, 16, v37
    v_lshl_or_b32 v69, v40, 16, v39
    v_lshl_or_b32 v70, v42, 16, v41
    v_lshl_or_b32 v71, v44, 16, v43
    v_lshl_or_b32 v72, v46, 16, v45
    v_lshl_or_b32 v73, v48, 16, v47
    v_lshl_or_b32 v76, v40, 16, v39
    v_lshl_or_b32 v77, v42, 16, v41
    v_lshl_or_b32 v78, v44, 16, v43
    v_lshl_or_b32 v79, v46, 16, v45
    v_lshl_or_b32 v80, v48, 16, v47
    v_lshl_or_b32 v81, v50, 16, v49
    ds_write_b128 v3, v[68:71] offset:58240
    ds_write_b128 v3, v[76:79] offset:49920
    ds_write_b128 v3, v[70:73] offset:41600
    ds_write_b128 v3, v[78:81] offset:33280
    v_mov_b32 v2, 0
    v_min_u32 v3, 15, v1
    v_lshlrev_b32 v3, 11, v3
    v_mov_b32 v5, 1
    s_lshl_b32 s34, s48, 16
    s_and_b32 s35, s48, 0xffff0000
    s_mov_b32 s47, 31719424
    s_cmp_eq_u32 s33, 0
    s_cselect_b32 s6, 0, 2130706432
    s_lshl_b32 s18, s28, 11
    s_sub_u32 s4, s26, s18
    s_add_u32 s4, s4, 2048
    s_add_u32 s26, s26, s18
    s_cmp_eq_u32 s33, 1
    s_cselect_b32 s7, 0, 2130706432
    v_min_u32 v3, 31, v1
    v_lshlrev_b32 v3, 11, v3
    s_or_b32 s18, s47, s7
    buffer_load_dword v4, v3, s[8:11], s18 offen sc1
    v_lshrrev_b32 v138, 3, v0
    v_lshlrev_b32 v138, 15, v138
    v_and_b32 v6, 7, v0
    v_lshl_add_u32 v138, v6, 3, v138
    v_lshlrev_b32 v139, 4, v0
    s_lshl_b32 s20, s2, 7
    s_add_u32 s20, s20, s41
    s_add_u32 s20, s20, 0
    s_add_u32 s21, s42, 0
    s_add_u32 s24, s21, 8192
    v_mov_b32 v36, 0
    v_mov_b32 v37, 0
    v_mov_b32 v38, 0
    v_mov_b32 v39, 0
    s_cmp_lg_u32 s33, 0
    s_cbranch_scc1 L_cvz_8
    v_lshrrev_b32 v6, 2, v1
    v_and_b32 v7, 3, v1
    v_mul_u32_u24 v9, 4160, v6
    v_lshl_add_u32 v9, v7, 4, v9
    ds_write_b128 v9, v[36:39] offset:4096
L_cvz_8:
    s_cmp_lg_u32 s33, 1
    s_cbranch_scc1 L_cvz_9
    v_lshrrev_b32 v6, 5, v1
    v_mul_u32_u24 v9, 4096, v6
    v_add_u32 v9, v9, v8
    v_add_u32 v9, 66560, v9
    ds_write_b128 v9, v[36:39]
L_cvz_9:
    v_and_b32 v10, 15, v1
    v_lshrrev_b32 v11, 4, v1
    v_and_b32 v132, 7, v1
    v_mul_u32_u24 v132, 4160, v132
    v_bfe_u32 v6, v1, 3, 1
    v_sub_u32 v6, v11, v6
    v_lshl_add_u32 v132, v6, 4, v132
    s_mul_i32 s30, s25, 33280
    s_lshl_b32 s31, s28, 8
    s_sub_u32 s30, s30, s31
    s_add_u32 s30, s30, 272
    v_add_u32 v132, s30, v132
    v_lshlrev_b32 v133, 5, v10
    v_lshl_add_u32 v133, v11, 4, v133
    s_mul_i32 s30, s25, 4608
    s_sub_u32 s30, s30, s31
    s_add_u32 s30, s30, 66848
    v_add_u32 v133, s30, v133
    v_lshlrev_b32 v134, 6, v10
    v_lshl_add_u32 v134, v11, 4, v134
    s_lshl_b32 s30, s25, 12
    s_lshl_b32 s31, s28, 11
    s_add_u32 s30, s30, s31
    s_add_u32 s30, s30, 75776
    v_add_u32 v134, s30, v134
    s_lshl_b32 s30, s33, 11
    s_add_u32 s30, s30, 83968
    v_add_u32 v135, s30, v8
    s_xor_b32 s30, s33, 1
    s_lshl_b32 s30, s30, 11
    s_add_u32 s30, s30, 83968
    v_add_u32 v136, s30, v8
    v_lshrrev_b32 v137, 2, v10
    v_and_b32 v6, 1, v11
    v_lshl_add_u32 v137, v6, 2, v137
    v_lshlrev_b32 v137, 16, v137
    v_and_b32 v6, 3, v10
    v_lshl_add_u32 v137, v6, 5, v137
    v_lshrrev_b32 v6, 5, v1
    v_lshl_add_u32 v137, v6, 4, v137
    v_lshlrev_b32 v140, 3, v0
    v_add_u32 v140, 67072, v140
    v_lshlrev_b32 v141, 4, v0
    v_add_u32 v141, 75776, v141
    s_cmp_lg_u32 s33, 1
    s_cbranch_scc1 L_spd_11
    s_waitcnt vmcnt(0)
    v_cmp_le_u32 vcc, 8, v4
    s_nop 1
    s_cmp_eq_u64 vcc, -1
    s_cbranch_scc1 L_spd_11
    s_mov_b32 s18, 200000
    buffer_load_dword v4, v3, s[8:11], s47 offen sc1
    s_sleep 4
L_sp_10:
    buffer_load_dword v4, v3, s[8:11], s47 offen sc1
    s_waitcnt vmcnt(1)
    v_cmp_le_u32 vcc, 8, v4
    s_nop 1
    s_cmp_eq_u64 vcc, -1
    s_cbranch_scc1 L_spd_11
    s_sub_u32 s18, s18, 1
    s_cmp_lg_u32 s18, 0
    s_cbranch_scc1 L_sp_10
L_spd_11:
    s_barrier
    buffer_load_dwordx4 v[144:147], v139, s[8:11], s21 offen sc1
    buffer_load_dwordx4 v[148:151], v139, s[8:11], s24 offen sc1
    buffer_load_dwordx2 v[152:153], v138, s[8:11], s20 offen sc1
    buffer_load_dwordx2 v[154:155], v138, s[8:11], s20 offen offset:64 sc1
    v_min_u32 v3, 15, v1
    v_lshlrev_b32 v3, 11, v3
    buffer_load_dword v4, v2, s[8:11], s44 offen
    buffer_load_dword v4, v2, s[8:11], s44 offen
L_layer:
    s_cmp_lg_u32 s40, 0
    s_cbranch_scc1 L_c_12
    s_add_u32 s39, s49, 0
    buffer_load_dwordx4 a[0:3], v8, s[8:11], s39 offen offset:0 sc1
    buffer_load_dwordx4 a[4:7], v8, s[8:11], s39 offen offset:1024 sc1
    buffer_load_dwordx4 a[8:11], v8, s[8:11], s39 offen offset:2048 sc1
    buffer_load_dwordx4 a[12:15], v8, s[8:11], s39 offen offset:3072 sc1
    s_add_u32 s39, s49, 4096
    buffer_load_dwordx4 a[16:19], v8, s[8:11], s39 offen offset:0 sc1
    buffer_load_dwordx4 a[20:23], v8, s[8:11], s39 offen offset:1024 sc1
    buffer_load_dwordx4 a[24:27], v8, s[8:11], s39 offen offset:2048 sc1
    buffer_load_dwordx4 a[28:31], v8, s[8:11], s39 offen offset:3072 sc1
    s_add_u32 s39, s49, 8192
    buffer_load_dwordx4 a[32:35], v8, s[8:11], s39 offen offset:0 sc1
    buffer_load_dwordx4 a[36:39], v8, s[8:11], s39 offen offset:1024 sc1
L_c_12:
    s_cmp_lg_u32 s40, 0
    s_cbranch_scc1 L_w_13
    s_waitcnt vmcnt(14)
    s_branch L_w_14
L_w_13:
    s_waitcnt vmcnt(4)
L_w_14:
    s_mov_b32 s36, 0x3b000000
    s_mov_b32 s38, 0x3727c5ac
    v_mul_f32 v144, s36, v144
    v_mul_f32 v145, s36, v145
    v_mul_f32 v146, s36, v146
    v_mul_f32 v147, s36, v147
    v_mul_f32 v148, s36, v148
    v_mul_f32 v149, s36, v149
    v_mul_f32 v150, s36, v150
    v_mul_f32 v151, s36, v151
    v_fma_f32 v148, -v144, v144, v148
    v_fma_f32 v149, -v145, v145, v149
    v_fma_f32 v150, -v146, v146, v150
    v_fma_f32 v151, -v147, v147, v151
    v_max_f32 v148, 0, v148
    v_max_f32 v149, 0, v149
    v_max_f32 v150, 0, v150
    v_max_f32 v151, 0, v151
    v_add_f32 v148, s38, v148
    v_add_f32 v149, s38, v149
    v_add_f32 v150, s38, v150
    v_add_f32 v151, s38, v151
    v_rsq_f32 v148, v148
    v_rsq_f32 v149, v149
    v_rsq_f32 v150, v150
    v_rsq_f32 v151, v151
    v_mul_f32 v144, v144, v148
    v_mul_f32 v145, v145, v149
    v_mul_f32 v146, v146, v150
    v_mul_f32 v147, v147, v151
    s_cmp_lg_u32 s40, 0
    s_cbranch_scc1 L_w_15
    s_waitcnt vmcnt(12)
    s_branch L_w_16
L_w_15:
    s_waitcnt vmcnt(2)
L_w_16:
    v_lshlrev_b32 v12, 16, v152
    v_and_b32 v13, 0xffff0000, v152
    v_lshlrev_b32 v14, 16, v153
    v_and_b32 v15, 0xffff0000, v153
    v_fma_f32 v16, v12, v148, -v144
    v_fma_f32 v17, v13, v149, -v145
    v_fma_f32 v18, v14, v150, -v146
    v_fma_f32 v19, v15, v151, -v147
    v_cvt_pk_bf16_f32 v28, v16, v17
    v_cvt_pk_bf16_f32 v29, v18, v19
    ds_write_b64 v140, v[28:29] offset:0
    v_fmac_f32 v12, s34, v16
    v_fmac_f32 v13, s34, v17
    v_fmac_f32 v14, s34, v18
    v_fmac_f32 v15, s34, v19
    ds_write_b128 v141, v[12:15] offset:0
    v_lshlrev_b32 v20, 16, v154
    v_and_b32 v21, 0xffff0000, v154
    v_lshlrev_b32 v22, 16, v155
    v_and_b32 v23, 0xffff0000, v155
    v_fma_f32 v24, v20, v148, -v144
    v_fma_f32 v25, v21, v149, -v145
    v_fma_f32 v26, v22, v150, -v146
    v_fma_f32 v27, v23, v151, -v147
    v_cvt_pk_bf16_f32 v30, v24, v25
    v_cvt_pk_bf16_f32 v31, v26, v27
    ds_write_b64 v140, v[30:31] offset:4608
    v_fmac_f32 v20, s35, v24
    v_fmac_f32 v21, s35, v25
    v_fmac_f32 v22, s35, v26
    v_fmac_f32 v23, s35, v27
    ds_write_b128 v141, v[20:23] offset:4096
    s_waitcnt lgkmcnt(0)
    s_barrier
    ds_read_b128 v[56:59], v132 offset:3776
    ds_read_b128 v[60:63], v133 offset:192
    ds_read_b128 v[64:67], v132 offset:3264
    ds_read_b128 v[68:71], v133 offset:704
    ds_read_b128 v[72:75], v132 offset:2752
    ds_read_b128 v[76:79], v133 offset:1216
    ds_read_b128 v[80:83], v132 offset:2240
    ds_read_b128 v[84:87], v133 offset:1728
    s_waitcnt lgkmcnt(6)
    v_mfma_f32_16x16x32_bf16 v[100:103], v[56:59], v[60:63], 0
    ds_read_b128 v[12:15], v132 offset:3712
    s_waitcnt lgkmcnt(6)
    v_mfma_f32_16x16x32_bf16 v[104:107], v[64:67], v[60:63], 0
    ds_read_b128 v[16:19], v133 offset:128
    s_waitcnt lgkmcnt(6)
    v_mfma_f32_16x16x32_bf16 v[104:107], v[56:59], v[68:71], v[104:107]
    ds_read_b128 v[20:23], v132 offset:3200
    v_mfma_f32_16x16x32_bf16 v[108:111], v[64:67], v[68:71], 0
    ds_read_b128 v[24:27], v133 offset:640
    s_waitcnt lgkmcnt(7)
    v_mfma_f32_16x16x32_bf16 v[108:111], v[72:75], v[60:63], v[108:111]
    ds_read_b128 v[28:31], v132 offset:2688
    s_waitcnt lgkmcnt(7)
    v_mfma_f32_16x16x32_bf16 v[108:111], v[56:59], v[76:79], v[108:111]
    ds_read_b128 v[32:35], v133 offset:1152
    v_mfma_f32_16x16x32_bf16 v[112:115], v[72:75], v[68:71], 0
    ds_read_b128 v[36:39], v132 offset:2176
    v_mfma_f32_16x16x32_bf16 v[112:115], v[64:67], v[76:79], v[112:115]
    ds_read_b128 v[40:43], v133 offset:1664
    s_waitcnt lgkmcnt(9)
    v_mfma_f32_16x16x32_bf16 v[112:115], v[80:83], v[60:63], v[112:115]
    s_waitcnt lgkmcnt(8)
    v_mfma_f32_16x16x32_bf16 v[112:115], v[56:59], v[84:87], v[112:115]
    s_waitcnt lgkmcnt(6)
    v_mfma_f32_16x16x32_bf16 v[100:103], v[12:15], v[16:19], v[100:103]
    ds_read_b128 v[56:59], v132 offset:3648
    s_waitcnt lgkmcnt(6)
    v_mfma_f32_16x16x32_bf16 v[104:107], v[20:23], v[16:19], v[104:107]
    ds_read_b128 v[60:63], v133 offset:64
    s_waitcnt lgkmcnt(6)
    v_mfma_f32_16x16x32_bf16 v[104:107], v[12:15], v[24:27], v[104:107]
    ds_read_b128 v[64:67], v132 offset:3136
    v_mfma_f32_16x16x32_bf16 v[108:111], v[20:23], v[24:27], v[108:111]
    ds_read_b128 v[68:71], v133 offset:576
    s_waitcnt lgkmcnt(7)
    v_mfma_f32_16x16x32_bf16 v[108:111], v[28:31], v[16:19], v[108:111]
    ds_read_b128 v[72:75], v132 offset:2624
    s_waitcnt lgkmcnt(7)
    v_mfma_f32_16x16x32_bf16 v[108:111], v[12:15], v[32:35], v[108:111]
    ds_read_b128 v[76:79], v133 offset:1088
    v_mfma_f32_16x16x32_bf16 v[112:115], v[28:31], v[24:27], v[112:115]
    ds_read_b128 v[80:83], v132 offset:2112
    v_mfma_f32_16x16x32_bf16 v[112:115], v[20:23], v[32:35], v[112:115]
    ds_read_b128 v[84:87], v133 offset:1600
    s_waitcnt lgkmcnt(9)
    v_mfma_f32_16x16x32_bf16 v[112:115], v[36:39], v[16:19], v[112:115]
    s_waitcnt lgkmcnt(8)
    v_mfma_f32_16x16x32_bf16 v[112:115], v[12:15], v[40:43], v[112:115]
    s_waitcnt lgkmcnt(6)
    v_mfma_f32_16x16x32_bf16 v[100:103], v[56:59], v[60:63], v[100:103]
    ds_read_b128 v[12:15], v132 offset:3584
    s_cmp_lg_u32 s40, 0
    s_cbranch_scc1 L_c_17
    s_add_u32 s39, s49, 8192
    buffer_load_dwordx4 a[40:43], v8, s[8:11], s39 offen offset:2048 sc1
    buffer_load_dwordx4 a[44:47], v8, s[8:11], s39 offen offset:3072 sc1
    s_add_u32 s39, s49, 12288
    buffer_load_dwordx4 a[48:51], v8, s[8:11], s39 offen offset:0 sc1
    buffer_load_dwordx4 a[52:55], v8, s[8:11], s39 offen offset:1024 sc1
L_c_17:
    s_waitcnt lgkmcnt(6)
    v_mfma_f32_16x16x32_bf16 v[104:107], v[64:67], v[60:63], v[104:107]
    ds_read_b128 v[16:19], v133 offset:0
    s_waitcnt lgkmcnt(6)
    v_mfma_f32_16x16x32_bf16 v[104:107], v[56:59], v[68:71], v[104:107]
    ds_read_b128 v[20:23], v132 offset:3072
    v_mfma_f32_16x16x32_bf16 v[108:111], v[64:67], v[68:71], v[108:111]
    ds_read_b128 v[24:27], v133 offset:512
    s_waitcnt lgkmcnt(7)
    v_mfma_f32_16x16x32_bf16 v[108:111], v[72:75], v[60:63], v[108:111]
    ds_read_b128 v[28:31], v132 offset:2560
    s_waitcnt lgkmcnt(7)
    v_mfma_f32_16x16x32_bf16 v[108:111], v[56:59], v[76:79], v[108:111]
    ds_read_b128 v[32:35], v133 offset:1024
    v_mfma_f32_16x16x32_bf16 v[112:115], v[72:75], v[68:71], v[112:115]
    ds_read_b128 v[36:39], v132 offset:2048
    v_mfma_f32_16x16x32_bf16 v[112:115], v[64:67], v[76:79], v[112:115]
    ds_read_b128 v[40:43], v133 offset:1536
    s_waitcnt lgkmcnt(9)
    v_mfma_f32_16x16x32_bf16 v[112:115], v[80:83], v[60:63], v[112:115]
    s_waitcnt lgkmcnt(8)
    v_mfma_f32_16x16x32_bf16 v[112:115], v[56:59], v[84:87], v[112:115]
    s_waitcnt lgkmcnt(6)
    v_mfma_f32_16x16x32_bf16 v[100:103], v[12:15], v[16:19], v[100:103]
    s_lshl_b32 s23, s2, 8
    s_add_u32 s23, s23, s43
    s_lshl_b32 s30, s25, 7
    s_add_u32 s23, s23, s30
    s_lshl_b32 s30, s28, 19
    s_add_u32 s23, s23, s30
    s_add_u32 s23, s23, 0
    s_waitcnt lgkmcnt(5)
    v_mfma_f32_16x16x32_bf16 v[104:107], v[20:23], v[16:19], v[104:107]
    ds_read_b128 v[64:67], v134
    ds_read_b128 v[68:71], v134 offset:1024
    s_waitcnt lgkmcnt(6)
    v_mfma_f32_16x16x32_bf16 v[104:107], v[12:15], v[24:27], v[104:107]
    v_mfma_f32_16x16x32_bf16 v[108:111], v[20:23], v[24:27], v[108:111]
    s_waitcnt lgkmcnt(5)
    v_mfma_f32_16x16x32_bf16 v[108:111], v[28:31], v[16:19], v[108:111]
    s_waitcnt lgkmcnt(4)
    v_mfma_f32_16x16x32_bf16 v[108:111], v[12:15], v[32:35], v[108:111]
    v_mfma_f32_16x16x32_bf16 v[112:115], v[28:31], v[24:27], v[112:115]
    v_mfma_f32_16x16x32_bf16 v[112:115], v[20:23], v[32:35], v[112:115]
    s_waitcnt lgkmcnt(3)
    v_mfma_f32_16x16x32_bf16 v[112:115], v[36:39], v[16:19], v[112:115]
    s_waitcnt lgkmcnt(2)
    v_mfma_f32_16x16x32_bf16 v[112:115], v[12:15], v[40:43], v[112:115]
    s_nop 5
    s_cmp_eq_u32 s28, 0
    s_cbranch_scc1 L_ck0_18
    ds_write_b128 v135, v[100:103]
    ds_write_b128 v135, v[104:107] offset:1024
    s_waitcnt lgkmcnt(2)
    v_add_f32 v56, v108, v64
    v_add_f32 v57, v109, v65
    v_add_f32 v58, v110, v66
    v_add_f32 v59, v111, v67
    v_add_f32 v60, v112, v68
    v_add_f32 v61, v113, v69
    v_add_f32 v62, v114, v70
    v_add_f32 v63, v115, v71
    s_branch L_ck1_19
L_ck0_18:
    ds_write_b128 v135, v[108:111]
    ds_write_b128 v135, v[112:115] offset:1024
    s_waitcnt lgkmcnt(2)
    v_add_f32 v56, v100, v64
    v_add_f32 v57, v101, v65
    v_add_f32 v58, v102, v66
    v_add_f32 v59, v103, v67
    v_add_f32 v60, v104, v68
    v_add_f32 v61, v105, v69
    v_add_f32 v62, v106, v70
    v_add_f32 v63, v107, v71
L_ck1_19:
    s_waitcnt lgkmcnt(0)
    s_barrier
    ds_read_b128 v[72:75], v136
    ds_read_b128 v[76:79], v136 offset:1024
    s_waitcnt lgkmcnt(1)
    v_add_f32 v56, v56, v72
    v_add_f32 v57, v57, v73
    v_add_f32 v58, v58, v74
    v_add_f32 v59, v59, v75
    v_cvt_pk_bf16_f32 v80, v56, v57
    v_cvt_pk_bf16_f32 v81, v58, v59
    s_waitcnt lgkmcnt(0)
    v_add_f32 v60, v60, v76
    v_add_f32 v61, v61, v77
    v_add_f32 v62, v62, v78
    v_add_f32 v63, v63, v79
    v_cvt_pk_bf16_f32 v82, v60, v61
    v_cvt_pk_bf16_f32 v83, v62, v63
    s_nop 0
    v_permlane16_swap_b32 v80, v82
    v_permlane16_swap_b32 v81, v83
    buffer_store_dwordx4 v[80:83], v137, s[8:11], s23 offen sc1
    ds_read_b128 v[12:15], v132 offset:1728
    ds_read_b128 v[16:19], v133 offset:192
    ds_read_b128 v[20:23], v132 offset:1216
    ds_read_b128 v[24:27], v133 offset:704
    ds_read_b128 v[28:31], v132 offset:2240
    ds_read_b128 v[32:35], v132 offset:704
    ds_read_b128 v[36:39], v133 offset:1216
    ds_read_b128 v[40:43], v132 offset:192
    ds_read_b128 v[44:47], v132 offset:2752
    ds_read_b128 v[48:51], v133 offset:1728
    ds_read_b128 v[52:55], v132 offset:3264
    s_waitcnt lgkmcnt(9)
    v_mfma_f32_16x16x32_bf16 v[116:119], v[12:15], v[16:19], 0
    ds_read_b128 v[56:59], v132 offset:1664
    s_waitcnt lgkmcnt(9)
    v_mfma_f32_16x16x32_bf16 v[120:123], v[20:23], v[16:19], 0
    ds_read_b128 v[60:63], v133 offset:128
    s_waitcnt lgkmcnt(9)
    v_mfma_f32_16x16x32_bf16 v[120:123], v[12:15], v[24:27], v[120:123]
    ds_read_b128 v[64:67], v132 offset:1152
    s_waitcnt lgkmcnt(9)
    v_mfma_f32_16x16x32_bf16 v[116:119], v[28:31], v[24:27], v[116:119]
    ds_read_b128 v[68:71], v133 offset:640
    s_waitcnt lgkmcnt(9)
    v_mfma_f32_16x16x32_bf16 v[124:127], v[32:35], v[16:19], 0
    ds_read_b128 v[72:75], v132 offset:2176
    s_cmp_lg_u32 s40, 0
    s_cbranch_scc1 L_c_20
    s_add_u32 s39, s49, 12288
    buffer_load_dwordx4 a[56:59], v8, s[8:11], s39 offen offset:2048 sc1
    buffer_load_dwordx4 a[60:63], v8, s[8:11], s39 offen offset:3072 sc1
    s_add_u32 s39, s49, 16384
    buffer_load_dwordx4 a[64:67], v8, s[8:11], s39 offen offset:0 sc1
    buffer_load_dwordx4 a[68:71], v8, s[8:11], s39 offen offset:1024 sc1
L_c_20:
    v_mfma_f32_16x16x32_bf16 v[124:127], v[20:23], v[24:27], v[124:127]
    ds_read_b128 v[76:79], v132 offset:640
    s_waitcnt lgkmcnt(10)
    v_mfma_f32_16x16x32_bf16 v[120:123], v[28:31], v[36:39], v[120:123]
    ds_read_b128 v[80:83], v133 offset:1152
    v_mfma_f32_16x16x32_bf16 v[124:127], v[12:15], v[36:39], v[124:127]
    ds_read_b128 v[84:87], v132 offset:128
    s_waitcnt lgkmcnt(11)
    v_mfma_f32_16x16x32_bf16 v[128:131], v[40:43], v[16:19], 0
    ds_read_b128 v[88:91], v132 offset:2688
    v_mfma_f32_16x16x32_bf16 v[128:131], v[32:35], v[24:27], v[128:131]
    ds_read_b128 v[92:95], v133 offset:1664
    v_mfma_f32_16x16x32_bf16 v[128:131], v[20:23], v[36:39], v[128:131]
    ds_read_b128 v[96:99], v132 offset:3200
    s_waitcnt lgkmcnt(13)
    v_mfma_f32_16x16x32_bf16 v[116:119], v[44:47], v[36:39], v[116:119]
    s_waitcnt lgkmcnt(12)
    v_mfma_f32_16x16x32_bf16 v[124:127], v[28:31], v[48:51], v[124:127]
    v_mfma_f32_16x16x32_bf16 v[128:131], v[12:15], v[48:51], v[128:131]
    v_mfma_f32_16x16x32_bf16 v[120:123], v[44:47], v[48:51], v[120:123]
    s_waitcnt lgkmcnt(11)
    v_mfma_f32_16x16x32_bf16 v[116:119], v[52:55], v[48:51], v[116:119]
    s_waitcnt lgkmcnt(9)
    v_mfma_f32_16x16x32_bf16 v[116:119], v[56:59], v[60:63], v[116:119]
    ds_read_b128 v[12:15], v132 offset:1600
    s_waitcnt lgkmcnt(9)
    v_mfma_f32_16x16x32_bf16 v[120:123], v[64:67], v[60:63], v[120:123]
    ds_read_b128 v[16:19], v133 offset:64
    s_waitcnt lgkmcnt(9)
    v_mfma_f32_16x16x32_bf16 v[120:123], v[56:59], v[68:71], v[120:123]
    ds_read_b128 v[20:23], v132 offset:1088
    s_waitcnt lgkmcnt(9)
    v_mfma_f32_16x16x32_bf16 v[116:119], v[72:75], v[68:71], v[116:119]
    ds_read_b128 v[24:27], v133 offset:576
    s_waitcnt lgkmcnt(9)
    v_mfma_f32_16x16x32_bf16 v[124:127], v[76:79], v[60:63], v[124:127]
    ds_read_b128 v[28:31], v132 offset:2112
    s_mov_b32 s47, 31817728
    s_or_b32 s18, s47, s7
    buffer_load_dword v4, v3, s[8:11], s18 offen sc1
    v_mfma_f32_16x16x32_bf16 v[124:127], v[64:67], v[68:71], v[124:127]
    ds_read_b128 v[32:35], v132 offset:576
    s_waitcnt lgkmcnt(10)
    v_mfma_f32_16x16x32_bf16 v[120:123], v[72:75], v[80:83], v[120:123]
    ds_read_b128 v[36:39], v133 offset:1088
    s_cmp_lg_u32 s40, 0
    s_cbranch_scc1 L_c_21
    s_add_u32 s39, s49, 16384
    buffer_load_dwordx4 a[72:75], v8, s[8:11], s39 offen offset:2048 sc1
    buffer_load_dwordx4 a[76:79], v8, s[8:11], s39 offen offset:3072 sc1
    s_add_u32 s39, s49, 20480
    buffer_load_dwordx4 a[80:83], v8, s[8:11], s39 offen offset:0 sc1
    buffer_load_dwordx4 a[84:87], v8, s[8:11], s39 offen offset:1024 sc1
L_c_21:
    v_mfma_f32_16x16x32_bf16 v[124:127], v[56:59], v[80:83], v[124:127]
    ds_read_b128 v[40:43], v132 offset:64
    s_waitcnt lgkmcnt(11)
    v_mfma_f32_16x16x32_bf16 v[128:131], v[84:87], v[60:63], v[128:131]
    ds_read_b128 v[44:47], v132 offset:2624
    s_add_u32 s3, s44, s27
    s_or_b32 s3, s3, s6
    s_cmp_lg_u32 s40, 0
    s_cbranch_scc1 L_w_22
    s_waitcnt vmcnt(9)
    s_branch L_w_23
L_w_22:
    s_waitcnt vmcnt(1)
L_w_23:
    s_barrier
    s_mov_b64 exec, 1
    buffer_atomic_add v5, v2, s[8:11], s3 offen sc1
    s_mov_b64 exec, -1
    v_mfma_f32_16x16x32_bf16 v[128:131], v[76:79], v[68:71], v[128:131]
    ds_read_b128 v[48:51], v133 offset:1600
    v_mfma_f32_16x16x32_bf16 v[128:131], v[64:67], v[80:83], v[128:131]
    ds_read_b128 v[52:55], v132 offset:3136
    s_waitcnt lgkmcnt(13)
    v_mfma_f32_16x16x32_bf16 v[116:119], v[88:91], v[80:83], v[116:119]
    s_waitcnt lgkmcnt(12)
    v_mfma_f32_16x16x32_bf16 v[124:127], v[72:75], v[92:95], v[124:127]
    v_mfma_f32_16x16x32_bf16 v[128:131], v[56:59], v[92:95], v[128:131]
    v_mfma_f32_16x16x32_bf16 v[120:123], v[88:91], v[92:95], v[120:123]
    s_waitcnt lgkmcnt(11)
    v_mfma_f32_16x16x32_bf16 v[116:119], v[96:99], v[92:95], v[116:119]
    s_waitcnt lgkmcnt(9)
    v_mfma_f32_16x16x32_bf16 v[116:119], v[12:15], v[16:19], v[116:119]
    ds_read_b128 v[56:59], v132 offset:1536
    s_waitcnt lgkmcnt(9)
    v_mfma_f32_16x16x32_bf16 v[120:123], v[20:23], v[16:19], v[120:123]
    ds_read_b128 v[60:63], v133 offset:0
    s_waitcnt lgkmcnt(9)
    v_mfma_f32_16x16x32_bf16 v[120:123], v[12:15], v[24:27], v[120:123]
    ds_read_b128 v[64:67], v132 offset:1024
    s_waitcnt lgkmcnt(9)
    v_mfma_f32_16x16x32_bf16 v[116:119], v[28:31], v[24:27], v[116:119]
    ds_read_b128 v[68:71], v133 offset:512
    s_waitcnt lgkmcnt(9)
    v_mfma_f32_16x16x32_bf16 v[124:127], v[32:35], v[16:19], v[124:127]
    ds_read_b128 v[72:75], v132 offset:2048
    s_lshl_b32 s20, s2, 7
    s_add_u32 s20, s20, s41
    s_add_u32 s20, s20, 1048576
    s_add_u32 s21, s42, 4096
    s_add_u32 s24, s21, 8192
    s_cmp_lg_u32 s40, 1
    s_cbranch_scc1 L_o_24
    s_cmp_lg_u32 s33, 1
    s_cbranch_scc1 L_spd_26
    s_waitcnt vmcnt(1)
    v_cmp_le_u32 vcc, 16, v4
    s_nop 1
    s_cmp_eq_u64 vcc, -1
    s_cbranch_scc1 L_spd_26
    s_mov_b32 s18, 200000
    buffer_load_dword v4, v3, s[8:11], s47 offen sc1
    s_sleep 4
L_sp_25:
    buffer_load_dword v4, v3, s[8:11], s47 offen sc1
    s_waitcnt vmcnt(1)
    v_cmp_le_u32 vcc, 16, v4
    s_nop 1
    s_cmp_eq_u64 vcc, -1
    s_cbranch_scc1 L_spd_26
    s_sub_u32 s18, s18, 1
    s_cmp_lg_u32 s18, 0
    s_cbranch_scc1 L_sp_25
L_spd_26:
    s_barrier
L_o_24:
    buffer_load_dwordx4 v[144:147], v139, s[8:11], s21 offen sc1
    buffer_load_dwordx4 v[148:151], v139, s[8:11], s24 offen sc1
    buffer_load_dwordx2 v[152:153], v138, s[8:11], s20 offen sc1
    buffer_load_dwordx2 v[154:155], v138, s[8:11], s20 offen offset:64 sc1
    v_mfma_f32_16x16x32_bf16 v[124:127], v[20:23], v[24:27], v[124:127]
    ds_read_b128 v[76:79], v132 offset:512
    s_waitcnt lgkmcnt(10)
    v_mfma_f32_16x16x32_bf16 v[120:123], v[28:31], v[36:39], v[120:123]
    ds_read_b128 v[80:83], v133 offset:1024
    v_mfma_f32_16x16x32_bf16 v[124:127], v[12:15], v[36:39], v[124:127]
    ds_read_b128 v[84:87], v132 offset:0
    s_waitcnt lgkmcnt(11)
    v_mfma_f32_16x16x32_bf16 v[128:131], v[40:43], v[16:19], v[128:131]
    ds_read_b128 v[88:91], v132 offset:2560
    v_mfma_f32_16x16x32_bf16 v[128:131], v[32:35], v[24:27], v[128:131]
    ds_read_b128 v[92:95], v133 offset:1536
    v_mfma_f32_16x16x32_bf16 v[128:131], v[20:23], v[36:39], v[128:131]
    ds_read_b128 v[96:99], v132 offset:3072
    s_waitcnt lgkmcnt(13)
    v_mfma_f32_16x16x32_bf16 v[116:119], v[44:47], v[36:39], v[116:119]
    s_waitcnt lgkmcnt(12)
    v_mfma_f32_16x16x32_bf16 v[124:127], v[28:31], v[48:51], v[124:127]
    v_mfma_f32_16x16x32_bf16 v[128:131], v[12:15], v[48:51], v[128:131]
    v_mfma_f32_16x16x32_bf16 v[120:123], v[44:47], v[48:51], v[120:123]
    s_waitcnt lgkmcnt(11)
    v_mfma_f32_16x16x32_bf16 v[116:119], v[52:55], v[48:51], v[116:119]
    s_waitcnt lgkmcnt(9)
    v_mfma_f32_16x16x32_bf16 v[116:119], v[56:59], v[60:63], v[116:119]
    s_waitcnt lgkmcnt(8)
    v_mfma_f32_16x16x32_bf16 v[120:123], v[64:67], v[60:63], v[120:123]
    s_waitcnt lgkmcnt(7)
    v_mfma_f32_16x16x32_bf16 v[120:123], v[56:59], v[68:71], v[120:123]
    s_waitcnt lgkmcnt(6)
    v_mfma_f32_16x16x32_bf16 v[116:119], v[72:75], v[68:71], v[116:119]
    s_waitcnt lgkmcnt(5)
    v_mfma_f32_16x16x32_bf16 v[124:127], v[76:79], v[60:63], v[124:127]
    v_mfma_f32_16x16x32_bf16 v[124:127], v[64:67], v[68:71], v[124:127]
    s_waitcnt lgkmcnt(4)
    v_mfma_f32_16x16x32_bf16 v[120:123], v[72:75], v[80:83], v[120:123]
    v_mfma_f32_16x16x32_bf16 v[124:127], v[56:59], v[80:83], v[124:127]
    s_waitcnt lgkmcnt(3)
    v_mfma_f32_16x16x32_bf16 v[128:131], v[84:87], v[60:63], v[128:131]
    v_mfma_f32_16x16x32_bf16 v[128:131], v[76:79], v[68:71], v[128:131]
    v_mfma_f32_16x16x32_bf16 v[128:131], v[64:67], v[80:83], v[128:131]
    s_waitcnt lgkmcnt(2)
    v_mfma_f32_16x16x32_bf16 v[116:119], v[88:91], v[80:83], v[116:119]
    s_waitcnt lgkmcnt(1)
    v_mfma_f32_16x16x32_bf16 v[124:127], v[72:75], v[92:95], v[124:127]
    s_cmp_lg_u32 s40, 0
    s_cbranch_scc1 L_c_27
    s_add_u32 s39, s49, 20480
    buffer_load_dwordx4 a[88:91], v8, s[8:11], s39 offen offset:2048 sc1
    buffer_load_dwordx4 a[92:95], v8, s[8:11], s39 offen offset:3072 sc1
    s_add_u32 s39, s49, 24576
    buffer_load_dwordx4 a[96:99], v8, s[8:11], s39 offen offset:0 sc1
    buffer_load_dwordx4 a[100:103], v8, s[8:11], s39 offen offset:1024 sc1
L_c_27:
    v_mfma_f32_16x16x32_bf16 v[128:131], v[56:59], v[92:95], v[128:131]
    v_mfma_f32_16x16x32_bf16 v[120:123], v[88:91], v[92:95], v[120:123]
    s_waitcnt lgkmcnt(0)
    v_mfma_f32_16x16x32_bf16 v[116:119], v[96:99], v[92:95], v[116:119]
    s_or_b32 s18, s44, s7
    buffer_load_dword v4, v3, s[8:11], s18 offen sc1
    s_cmp_lg_u32 s40, 0
    s_cbranch_scc1 L_c_28
    s_add_u32 s39, s49, 24576
    buffer_load_dwordx4 a[104:107], v8, s[8:11], s39 offen offset:2048 sc1
    buffer_load_dwordx4 a[108:111], v8, s[8:11], s39 offen offset:3072 sc1
    s_add_u32 s39, s49, 28672
    buffer_load_dwordx4 a[112:115], v8, s[8:11], s39 offen offset:0 sc1
    buffer_load_dwordx4 a[116:119], v8, s[8:11], s39 offen offset:1024 sc1
    buffer_load_dwordx4 a[120:123], v8, s[8:11], s39 offen offset:2048 sc1
    buffer_load_dwordx4 a[124:127], v8, s[8:11], s39 offen offset:3072 sc1
L_c_28:
    s_cmp_lg_u32 s40, 0
    s_cbranch_scc1 L_w_29
    s_waitcnt vmcnt(13)
    s_branch L_w_30
L_w_29:
    s_waitcnt vmcnt(3)
L_w_30:
    s_mov_b32 s36, 0x3b000000
    s_mov_b32 s38, 0x3727c5ac
    v_mul_f32 v144, s36, v144
    v_mul_f32 v145, s36, v145
    v_mul_f32 v146, s36, v146
    v_mul_f32 v147, s36, v147
    v_mul_f32 v148, s36, v148
    v_mul_f32 v149, s36, v149
    v_mul_f32 v150, s36, v150
    v_mul_f32 v151, s36, v151
    v_fma_f32 v148, -v144, v144, v148
    v_fma_f32 v149, -v145, v145, v149
    v_fma_f32 v150, -v146, v146, v150
    v_fma_f32 v151, -v147, v147, v151
    v_max_f32 v148, 0, v148
    v_max_f32 v149, 0, v149
    v_max_f32 v150, 0, v150
    v_max_f32 v151, 0, v151
    v_add_f32 v148, s38, v148
    v_add_f32 v149, s38, v149
    v_add_f32 v150, s38, v150
    v_add_f32 v151, s38, v151
    v_rsq_f32 v148, v148
    v_rsq_f32 v149, v149
    v_rsq_f32 v150, v150
    v_rsq_f32 v151, v151
    v_mul_f32 v144, v144, v148
    v_mul_f32 v145, v145, v149
    v_mul_f32 v146, v146, v150
    v_mul_f32 v147, v147, v151
    s_cmp_lg_u32 s40, 0
    s_cbranch_scc1 L_w_31
    s_waitcnt vmcnt(11)
    s_branch L_w_32
L_w_31:
    s_waitcnt vmcnt(1)
L_w_32:
    v_lshlrev_b32 v12, 16, v152
    v_and_b32 v13, 0xffff0000, v152
    v_lshlrev_b32 v14, 16, v153
    v_and_b32 v15, 0xffff0000, v153
    v_fma_f32 v16, v12, v148, -v144
    v_fma_f32 v17, v13, v149, -v145
    v_fma_f32 v18, v14, v150, -v146
    v_fma_f32 v19, v15, v151, -v147
    v_cvt_pk_bf16_f32 v28, v16, v17
    v_cvt_pk_bf16_f32 v29, v18, v19
    ds_write_b64 v140, v[28:29] offset:2048
    v_fmac_f32 v12, s34, v16
    v_fmac_f32 v13, s34, v17
    v_fmac_f32 v14, s34, v18
    v_fmac_f32 v15, s34, v19
    ds_write_b128 v141, v[12:15] offset:0
    v_lshlrev_b32 v20, 16, v154
    v_and_b32 v21, 0xffff0000, v154
    v_lshlrev_b32 v22, 16, v155
    v_and_b32 v23, 0xffff0000, v155
    v_fma_f32 v24, v20, v148, -v144
    v_fma_f32 v25, v21, v149, -v145
    v_fma_f32 v26, v22, v150, -v146
    v_fma_f32 v27, v23, v151, -v147
    v_cvt_pk_bf16_f32 v30, v24, v25
    v_cvt_pk_bf16_f32 v31, v26, v27
    ds_write_b64 v140, v[30:31] offset:6656
    v_fmac_f32 v20, s35, v24
    v_fmac_f32 v21, s35, v25
    v_fmac_f32 v22, s35, v26
    v_fmac_f32 v23, s35, v27
    ds_write_b128 v141, v[20:23] offset:4096
    v_lshrrev_b32 v6, 3, v1
    v_bfe_u32 v7, v1, 4, 1
    v_lshlrev_b32 v7, 1, v7
    v_and_b32 v9, 7, v1
    v_xor_b32 v9, v9, v7
    v_lshlrev_b32 v9, 4, v9
    v_lshl_add_u32 v9, v6, 7, v9
    v_xor_b32 v10, 0x40, v9
    s_lshl_b32 s21, s33, 12
    s_waitcnt lgkmcnt(0)
    ds_read_b128 v[56:59], v132 offset:3776
    ds_read_b128 v[64:67], v132 offset:3264
    ds_read_b128 v[72:75], v132 offset:2752
    ds_read_b128 v[80:83], v132 offset:2240
    s_barrier
    ds_read_b128 v[60:63], v133 offset:2240
    ds_read_b128 v[68:71], v133 offset:2752
    ds_read_b128 v[76:79], v133 offset:3264
    ds_read_b128 v[84:87], v133 offset:3776
    s_waitcnt lgkmcnt(3)
    v_mfma_f32_16x16x32_bf16 v[116:119], v[56:59], v[60:63], v[116:119]
    ds_read_b128 v[12:15], v132 offset:3712
    v_mfma_f32_16x16x32_bf16 v[120:123], v[64:67], v[60:63], v[120:123]
    ds_read_b128 v[16:19], v133 offset:2176
    s_waitcnt lgkmcnt(4)
    v_mfma_f32_16x16x32_bf16 v[120:123], v[56:59], v[68:71], v[120:123]
    ds_read_b128 v[20:23], v132 offset:3200
    v_mfma_f32_16x16x32_bf16 v[124:127], v[64:67], v[68:71], v[124:127]
    ds_read_b128 v[24:27], v133 offset:2688
    v_mfma_f32_16x16x32_bf16 v[124:127], v[72:75], v[60:63], v[124:127]
    ds_read_b128 v[28:31], v132 offset:2688
    s_cmp_lg_u32 s40, 0
    s_cbranch_scc1 L_c_33
    s_add_u32 s37, s26, 0
    s_add_u32 s36, s4, 0
    buffer_load_dwordx4 a[128:131], v8, s[8:11], s37 offen offset:0 sc1
    buffer_load_dwordx4 a[132:135], v8, s[8:11], s37 offen offset:1024 sc1
    buffer_load_dwordx4 a[136:139], v8, s[8:11], s36 offen offset:0 sc1
    buffer_load_dwordx4 a[140:143], v8, s[8:11], s36 offen offset:1024 sc1
    s_add_u32 s37, s26, 4096
    s_add_u32 s36, s4, 4096
    buffer_load_dwordx4 a[144:147], v8, s[8:11], s37 offen offset:0 sc1
    buffer_load_dwordx4 a[148:151], v8, s[8:11], s37 offen offset:1024 sc1
L_c_33:
    s_waitcnt lgkmcnt(6)
    v_mfma_f32_16x16x32_bf16 v[124:127], v[56:59], v[76:79], v[124:127]
    ds_read_b128 v[32:35], v133 offset:3200
    v_mfma_f32_16x16x32_bf16 v[128:131], v[72:75], v[68:71], v[128:131]
    ds_read_b128 v[36:39], v132 offset:2176
    v_mfma_f32_16x16x32_bf16 v[128:131], v[64:67], v[76:79], v[128:131]
    ds_read_b128 v[40:43], v133 offset:3712
    v_mfma_f32_16x16x32_bf16 v[128:131], v[80:83], v[60:63], v[128:131]
    s_lshl_b32 s23, s2, 8
    s_add_u32 s23, s23, s43
    s_lshl_b32 s30, s25, 7
    s_add_u32 s23, s23, s30
    s_lshl_b32 s30, s28, 19
    s_add_u32 s23, s23, s30
    s_add_u32 s23, s23, 1048576
    s_waitcnt lgkmcnt(8)
    v_mfma_f32_16x16x32_bf16 v[128:131], v[56:59], v[84:87], v[128:131]
    s_waitcnt lgkmcnt(6)
    v_mfma_f32_16x16x32_bf16 v[116:119], v[12:15], v[16:19], v[116:119]
    ds_read_b128 v[56:59], v132 offset:3648
    s_waitcnt lgkmcnt(6)
    v_mfma_f32_16x16x32_bf16 v[120:123], v[20:23], v[16:19], v[120:123]
    ds_read_b128 v[60:63], v133 offset:2112
    s_waitcnt lgkmcnt(6)
    v_mfma_f32_16x16x32_bf16 v[120:123], v[12:15], v[24:27], v[120:123]
    ds_read_b128 v[64:67], v132 offset:3136
    v_mfma_f32_16x16x32_bf16 v[124:127], v[20:23], v[24:27], v[124:127]
    ds_read_b128 v[68:71], v133 offset:2624
    s_waitcnt lgkmcnt(7)
    v_mfma_f32_16x16x32_bf16 v[124:127], v[28:31], v[16:19], v[124:127]
    ds_read_b128 v[72:75], v132 offset:2624
    s_waitcnt lgkmcnt(7)
    v_mfma_f32_16x16x32_bf16 v[124:127], v[12:15], v[32:35], v[124:127]
    ds_read_b128 v[76:79], v133 offset:3136
    v_mfma_f32_16x16x32_bf16 v[128:131], v[28:31], v[24:27], v[128:131]
    ds_read_b128 v[80:83], v132 offset:2112
    v_mfma_f32_16x16x32_bf16 v[128:131], v[20:23], v[32:35], v[128:131]
    ds_read_b128 v[84:87], v133 offset:3648
    s_waitcnt lgkmcnt(9)
    v_mfma_f32_16x16x32_bf16 v[128:131], v[36:39], v[16:19], v[128:131]
    s_waitcnt lgkmcnt(8)
    v_mfma_f32_16x16x32_bf16 v[128:131], v[12:15], v[40:43], v[128:131]
    s_waitcnt lgkmcnt(6)
    v_mfma_f32_16x16x32_bf16 v[116:119], v[56:59], v[60:63], v[116:119]
    ds_read_b128 v[12:15], v132 offset:3584
    s_waitcnt lgkmcnt(6)
    v_mfma_f32_16x16x32_bf16 v[120:123], v[64:67], v[60:63], v[120:123]
    ds_read_b128 v[16:19], v133 offset:2048
    s_waitcnt lgkmcnt(6)
    v_mfma_f32_16x16x32_bf16 v[120:123], v[56:59], v[68:71], v[120:123]
    ds_read_b128 v[20:23], v132 offset:3072
    v_mfma_f32_16x16x32_bf16 v[124:127], v[64:67], v[68:71], v[124:127]
    ds_read_b128 v[24:27], v133 offset:2560
    s_waitcnt lgkmcnt(7)
    v_mfma_f32_16x16x32_bf16 v[124:127], v[72:75], v[60:63], v[124:127]
    ds_read_b128 v[28:31], v132 offset:2560
    s_cmp_lg_u32 s33, 1
    s_cbranch_scc1 L_spd_35
    s_cmp_lg_u32 s40, 0
    s_cbranch_scc1 L_w_36
    s_waitcnt vmcnt(12)
    s_branch L_w_37
L_w_36:
    s_waitcnt vmcnt(0)
L_w_37:
    v_cmp_le_u32 vcc, 16, v4
    s_nop 1
    s_cmp_eq_u64 vcc, -1
    s_cbranch_scc1 L_spd_35
    s_mov_b32 s18, 200000
    buffer_load_dword v4, v3, s[8:11], s44 offen sc1
    s_sleep 4
L_sp_34:
    buffer_load_dword v4, v3, s[8:11], s44 offen sc1
    s_waitcnt vmcnt(1)
    v_cmp_le_u32 vcc, 16, v4
    s_nop 1
    s_cmp_eq_u64 vcc, -1
    s_cbranch_scc1 L_spd_35
    s_sub_u32 s18, s18, 1
    s_cmp_lg_u32 s18, 0
    s_cbranch_scc1 L_sp_34
L_spd_35:
    s_barrier
    s_lshl_b32 s20, s50, 16
    s_add_u32 s20, s20, s43
    s_add_u32 s20, s20, s21
    s_add_u32 s20, s20, 0
    s_cmp_ge_u32 s17, 28
    s_cselect_b32 s20, 0x7f000000, s20
    s_add_u32 m0, s21, 98304
    s_add_u32 s22, s20, 0
    buffer_load_dwordx4 v9, s[8:11], s22 offen offset:0 sc1 lds
    buffer_load_dwordx4 v10, s[8:11], s22 offen offset:1024 sc1 lds
    s_waitcnt lgkmcnt(7)
    v_mfma_f32_16x16x32_bf16 v[124:127], v[56:59], v[76:79], v[124:127]
    ds_read_b128 v[32:35], v133 offset:3072
    v_mfma_f32_16x16x32_bf16 v[128:131], v[72:75], v[68:71], v[128:131]
    ds_read_b128 v[36:39], v132 offset:2048
    v_mfma_f32_16x16x32_bf16 v[128:131], v[64:67], v[76:79], v[128:131]
    ds_read_b128 v[40:43], v133 offset:3584
    buffer_load_dwordx4 v9, s[8:11], s22 offen offset:2048 sc1 lds
    s_waitcnt lgkmcnt(9)
    v_mfma_f32_16x16x32_bf16 v[128:131], v[80:83], v[60:63], v[128:131]
    s_waitcnt lgkmcnt(8)
    v_mfma_f32_16x16x32_bf16 v[128:131], v[56:59], v[84:87], v[128:131]
    s_waitcnt lgkmcnt(6)
    v_mfma_f32_16x16x32_bf16 v[116:119], v[12:15], v[16:19], v[116:119]
    buffer_load_dwordx4 v10, s[8:11], s22 offen offset:3072 sc1 lds
    s_waitcnt lgkmcnt(5)
    v_mfma_f32_16x16x32_bf16 v[120:123], v[20:23], v[16:19], v[120:123]
    ds_read_b128 v[64:67], v134
    ds_read_b128 v[68:71], v134 offset:1024
    s_waitcnt lgkmcnt(6)
    v_mfma_f32_16x16x32_bf16 v[120:123], v[12:15], v[24:27], v[120:123]
    v_mfma_f32_16x16x32_bf16 v[124:127], v[20:23], v[24:27], v[124:127]
    s_add_u32 m0, s21, 114688
    s_add_u32 s22, s20, 16384
    buffer_load_dwordx4 v9, s[8:11], s22 offen offset:0 sc1 lds
    s_waitcnt lgkmcnt(5)
    v_mfma_f32_16x16x32_bf16 v[124:127], v[28:31], v[16:19], v[124:127]
    s_waitcnt lgkmcnt(4)
    v_mfma_f32_16x16x32_bf16 v[124:127], v[12:15], v[32:35], v[124:127]
    v_mfma_f32_16x16x32_bf16 v[128:131], v[28:31], v[24:27], v[128:131]
    buffer_load_dwordx4 v10, s[8:11], s22 offen offset:1024 sc1 lds
    v_mfma_f32_16x16x32_bf16 v[128:131], v[20:23], v[32:35], v[128:131]
    s_waitcnt lgkmcnt(3)
    v_mfma_f32_16x16x32_bf16 v[128:131], v[36:39], v[16:19], v[128:131]
    s_waitcnt lgkmcnt(2)
    v_mfma_f32_16x16x32_bf16 v[128:131], v[12:15], v[40:43], v[128:131]
    buffer_load_dwordx4 v9, s[8:11], s22 offen offset:2048 sc1 lds
    s_nop 5
    s_cmp_eq_u32 s28, 0
    s_cbranch_scc1 L_ck0_38
    ds_write_b128 v135, v[116:119]
    ds_write_b128 v135, v[120:123] offset:1024
    s_waitcnt lgkmcnt(2)
    v_add_f32 v56, v124, v64
    v_add_f32 v57, v125, v65
    v_add_f32 v58, v126, v66
    v_add_f32 v59, v127, v67
    v_add_f32 v60, v128, v68
    v_add_f32 v61, v129, v69
    v_add_f32 v62, v130, v70
    v_add_f32 v63, v131, v71
    s_branch L_ck1_39
L_ck0_38:
    ds_write_b128 v135, v[124:127]
    ds_write_b128 v135, v[128:131] offset:1024
    s_waitcnt lgkmcnt(2)
    v_add_f32 v56, v116, v64
    v_add_f32 v57, v117, v65
    v_add_f32 v58, v118, v66
    v_add_f32 v59, v119, v67
    v_add_f32 v60, v120, v68
    v_add_f32 v61, v121, v69
    v_add_f32 v62, v122, v70
    v_add_f32 v63, v123, v71
L_ck1_39:
    buffer_load_dwordx4 v10, s[8:11], s22 offen offset:3072 sc1 lds
    s_add_u32 m0, s21, 131072
    s_add_u32 s22, s20, 32768
    buffer_load_dwordx4 v9, s[8:11], s22 offen offset:0 sc1 lds
    s_waitcnt lgkmcnt(0)
    s_barrier
    ds_read_b128 v[72:75], v136
    ds_read_b128 v[76:79], v136 offset:1024
    buffer_load_dwordx4 v10, s[8:11], s22 offen offset:1024 sc1 lds
    buffer_load_dwordx4 v9, s[8:11], s22 offen offset:2048 sc1 lds
    s_waitcnt lgkmcnt(1)
    v_add_f32 v56, v56, v72
    v_add_f32 v57, v57, v73
    v_add_f32 v58, v58, v74
    v_add_f32 v59, v59, v75
    v_cvt_pk_bf16_f32 v80, v56, v57
    v_cvt_pk_bf16_f32 v81, v58, v59
    s_waitcnt lgkmcnt(0)
    v_add_f32 v60, v60, v76
    v_add_f32 v61, v61, v77
    v_add_f32 v62, v62, v78
    v_add_f32 v63, v63, v79
    v_cvt_pk_bf16_f32 v82, v60, v61
    v_cvt_pk_bf16_f32 v83, v62, v63
    s_nop 0
    v_permlane16_swap_b32 v80, v82
    v_permlane16_swap_b32 v81, v83
    buffer_store_dwordx4 v[80:83], v137, s[8:11], s23 offen sc1
    s_cmp_lg_u32 s40, 0
    s_cbranch_scc1 L_cs_40
    s_waitcnt vmcnt(18)
    v_mov_b32 v12, 0x3f803f80
    v_mov_b32 v13, 0x3f803f80
    v_mov_b32 v14, 0x3f803f80
    v_mov_b32 v15, 0x3f803f80
    s_nop 1
    v_mfma_f32_16x16x32_bf16 v[16:19], a[0:3], v[12:15], 0
    v_mfma_f32_16x16x32_bf16 v[20:23], a[4:7], v[12:15], 0
    v_mfma_f32_16x16x32_bf16 v[16:19], a[8:11], v[12:15], v[16:19]
    v_mfma_f32_16x16x32_bf16 v[20:23], a[12:15], v[12:15], v[20:23]
    v_mfma_f32_16x16x32_bf16 v[16:19], a[16:19], v[12:15], v[16:19]
    v_mfma_f32_16x16x32_bf16 v[20:23], a[20:23], v[12:15], v[20:23]
    v_mfma_f32_16x16x32_bf16 v[16:19], a[24:27], v[12:15], v[16:19]
    v_mfma_f32_16x16x32_bf16 v[20:23], a[28:31], v[12:15], v[20:23]
    v_mfma_f32_16x16x32_bf16 v[16:19], a[32:35], v[12:15], v[16:19]
    v_mfma_f32_16x16x32_bf16 v[20:23], a[36:39], v[12:15], v[20:23]
    v_mfma_f32_16x16x32_bf16 v[16:19], a[40:43], v[12:15], v[16:19]
    v_mfma_f32_16x16x32_bf16 v[20:23], a[44:47], v[12:15], v[20:23]
    v_mfma_f32_16x16x32_bf16 v[16:19], a[48:51], v[12:15], v[16:19]
    v_mfma_f32_16x16x32_bf16 v[20:23], a[52:55], v[12:15], v[20:23]
    v_mfma_f32_16x16x32_bf16 v[16:19], a[56:59], v[12:15], v[16:19]
    v_mfma_f32_16x16x32_bf16 v[20:23], a[60:63], v[12:15], v[20:23]
    v_mfma_f32_16x16x32_bf16 v[16:19], a[64:67], v[12:15], v[16:19]
    v_mfma_f32_16x16x32_bf16 v[20:23], a[68:71], v[12:15], v[20:23]
    v_mfma_f32_16x16x32_bf16 v[16:19], a[72:75], v[12:15], v[16:19]
    v_mfma_f32_16x16x32_bf16 v[20:23], a[76:79], v[12:15], v[20:23]
    v_mfma_f32_16x16x32_bf16 v[16:19], a[80:83], v[12:15], v[16:19]
    v_mfma_f32_16x16x32_bf16 v[20:23], a[84:87], v[12:15], v[20:23]
    v_mfma_f32_16x16x32_bf16 v[16:19], a[88:91], v[12:15], v[16:19]
    v_mfma_f32_16x16x32_bf16 v[20:23], a[92:95], v[12:15], v[20:23]
    v_mfma_f32_16x16x32_bf16 v[16:19], a[96:99], v[12:15], v[16:19]
    v_mfma_f32_16x16x32_bf16 v[20:23], a[100:103], v[12:15], v[20:23]
    v_mfma_f32_16x16x32_bf16 v[16:19], a[104:107], v[12:15], v[16:19]
    v_mfma_f32_16x16x32_bf16 v[20:23], a[108:111], v[12:15], v[20:23]
    v_mfma_f32_16x16x32_bf16 v[16:19], a[112:115], v[12:15], v[16:19]
    v_mfma_f32_16x16x32_bf16 v[20:23], a[116:119], v[12:15], v[20:23]
    v_mfma_f32_16x16x32_bf16 v[16:19], a[120:123], v[12:15], v[16:19]
    v_mfma_f32_16x16x32_bf16 v[20:23], a[124:127], v[12:15], v[20:23]
    v_lshrrev_b32 v6, 4, v1
    s_lshl_b32 s18, s33, 7
    s_add_u32 s18, s18, 95232
    v_lshl_add_u32 v6, v6, 5, s18
    s_nop 2
    ds_write_b128 v6, v[16:19]
    ds_write_b128 v6, v[20:23] offset:16
L_cs_40:
    buffer_load_dwordx4 v10, s[8:11], s22 offen offset:3072 sc1 lds
    s_add_u32 m0, s21, 147456
    s_add_u32 s22, s20, 49152
    buffer_load_dwordx4 v9, s[8:11], s22 offen offset:0 sc1 lds
    buffer_load_dwordx4 v10, s[8:11], s22 offen offset:1024 sc1 lds
    buffer_load_dwordx4 v9, s[8:11], s22 offen offset:2048 sc1 lds
    buffer_load_dwordx4 v10, s[8:11], s22 offen offset:3072 sc1 lds
    s_cmp_lg_u32 s40, 0
    s_cbranch_scc1 L_c_41
    s_add_u32 s37, s26, 4096
    s_add_u32 s36, s4, 4096
    buffer_load_dwordx4 a[152:155], v8, s[8:11], s36 offen offset:0 sc1
    buffer_load_dwordx4 a[156:159], v8, s[8:11], s36 offen offset:1024 sc1
    s_add_u32 s37, s26, 8192
    s_add_u32 s36, s4, 8192
    buffer_load_dwordx4 a[160:163], v8, s[8:11], s37 offen offset:0 sc1
    buffer_load_dwordx4 a[164:167], v8, s[8:11], s37 offen offset:1024 sc1
    buffer_load_dwordx4 a[168:171], v8, s[8:11], s36 offen offset:0 sc1
    buffer_load_dwordx4 a[172:175], v8, s[8:11], s36 offen offset:1024 sc1
    s_add_u32 s37, s26, 12288
    s_add_u32 s36, s4, 12288
    buffer_load_dwordx4 a[176:179], v8, s[8:11], s37 offen offset:0 sc1
    buffer_load_dwordx4 a[180:183], v8, s[8:11], s37 offen offset:1024 sc1
    buffer_load_dwordx4 a[184:187], v8, s[8:11], s36 offen offset:0 sc1
    buffer_load_dwordx4 a[188:191], v8, s[8:11], s36 offen offset:1024 sc1
L_c_41:
    v_lshrrev_b32 v11, 4, v1
    v_bfe_u32 v6, v1, 2, 2
    v_and_b32 v7, 3, v1
    v_lshl_add_u32 v16, v11, 3, v6
    v_lshlrev_b32 v16, 7, v16
    v_lshl_add_u32 v16, v7, 3, v16
    v_and_b32 v7, 1, v11
    v_lshrrev_b32 v6, 1, v6
    v_lshl_add_u32 v6, v7, 1, v6
    v_lshl_add_u32 v16, v6, 5, v16
    v_xor_b32 v17, 32, v16
    v_xor_b32 v18, 64, v16
    v_xor_b32 v19, 96, v16
    v_add_u32 v12, 98304, v16
    v_add_u32 v13, 98304, v17
    v_add_u32 v14, 98304, v18
    v_add_u32 v15, 98304, v19
    v_lshlrev_b32 v20, 4, v11
    v_and_b32 v21, 15, v1
    v_lshlrev_b32 v21, 3, v21
    s_lshl_b32 s18, s33, 7
    s_add_u32 s18, s18, 95232
    v_lshl_add_u32 v6, v20, 1, s18
    ds_read_b128 v[32:35], v6
    ds_read_b128 v[36:39], v6 offset:16
    s_add_u32 s3, s44, s27
    s_add_u32 s3, s3, 0x8000
    s_or_b32 s3, s3, s6
    s_cmp_lg_u32 s40, 0
    s_cbranch_scc1 L_w_42
    s_waitcnt vmcnt(15)
    s_branch L_w_43
L_w_42:
    s_waitcnt vmcnt(5)
L_w_43:
    s_barrier
    s_mov_b64 exec, 1
    buffer_atomic_add v5, v2, s[8:11], s3 offen sc1
    s_mov_b64 exec, -1
    s_cmp_ge_u32 s17, 28
    s_cbranch_scc1 L_stats
    ds_read_b64_tr_b16 v[64:65], v12 offset:0
    ds_read_b64_tr_b16 v[66:67], v12 offset:512
    ds_read_b64_tr_b16 v[68:69], v13 offset:0
    ds_read_b64_tr_b16 v[70:71], v13 offset:512
    ds_read_b64_tr_b16 v[72:73], v14 offset:0
    ds_read_b64_tr_b16 v[74:75], v14 offset:512
    ds_read_b64_tr_b16 v[76:77], v15 offset:0
    ds_read_b64_tr_b16 v[78:79], v15 offset:512
    ds_read_b64_tr_b16 v[80:81], v12 offset:4096
    ds_read_b64_tr_b16 v[82:83], v12 offset:4608
    ds_read_b64_tr_b16 v[84:85], v13 offset:4096
    ds_read_b64_tr_b16 v[86:87], v13 offset:4608
    ds_read_b64_tr_b16 v[88:89], v14 offset:4096
    ds_read_b64_tr_b16 v[90:91], v14 offset:4608
    ds_read_b64_tr_b16 v[92:93], v15 offset:4096
    ds_read_b64_tr_b16 v[94:95], v15 offset:4608
    s_waitcnt lgkmcnt(12)
    v_mfma_f32_16x16x32_bf16 v[112:115], a[0:3], v[64:67], 0
    ds_read_b64_tr_b16 v[96:97], v12 offset:8192
    v_mfma_f32_16x16x32_bf16 v[116:119], a[4:7], v[64:67], 0
    ds_read_b64_tr_b16 v[98:99], v12 offset:8704
    v_mfma_f32_16x16x32_bf16 v[120:123], a[0:3], v[68:71], 0
    ds_read_b64_tr_b16 v[100:101], v13 offset:8192
    v_mfma_f32_16x16x32_bf16 v[124:127], a[4:7], v[68:71], 0
    ds_read_b64_tr_b16 v[102:103], v13 offset:8704
    s_waitcnt lgkmcnt(12)
    v_mfma_f32_16x16x32_bf16 v[128:131], a[0:3], v[72:75], 0
    ds_read_b64_tr_b16 v[104:105], v14 offset:8192
    v_mfma_f32_16x16x32_bf16 v[132:135], a[4:7], v[72:75], 0
    ds_read_b64_tr_b16 v[106:107], v14 offset:8704
    v_mfma_f32_16x16x32_bf16 v[136:139], a[0:3], v[76:79], 0
    ds_read_b64_tr_b16 v[108:109], v15 offset:8192
    v_mfma_f32_16x16x32_bf16 v[140:143], a[4:7], v[76:79], 0
    ds_read_b64_tr_b16 v[110:111], v15 offset:8704
    s_waitcnt lgkmcnt(12)
    v_mfma_f32_16x16x32_bf16 v[112:115], a[8:11], v[80:83], v[112:115]
    ds_read_b64_tr_b16 v[64:65], v12 offset:12288
    v_mfma_f32_16x16x32_bf16 v[116:119], a[12:15], v[80:83], v[116:119]
    ds_read_b64_tr_b16 v[66:67], v12 offset:12800
    v_mfma_f32_16x16x32_bf16 v[120:123], a[8:11], v[84:87], v[120:123]
    ds_read_b64_tr_b16 v[68:69], v13 offset:12288
    v_mfma_f32_16x16x32_bf16 v[124:127], a[12:15], v[84:87], v[124:127]
    ds_read_b64_tr_b16 v[70:71], v13 offset:12800
    s_waitcnt lgkmcnt(12)
    v_mfma_f32_16x16x32_bf16 v[128:131], a[8:11], v[88:91], v[128:131]
    ds_read_b64_tr_b16 v[72:73], v14 offset:12288
    v_mfma_f32_16x16x32_bf16 v[132:135], a[12:15], v[88:91], v[132:135]
    ds_read_b64_tr_b16 v[74:75], v14 offset:12800
    v_mfma_f32_16x16x32_bf16 v[136:139], a[8:11], v[92:95], v[136:139]
    ds_read_b64_tr_b16 v[76:77], v15 offset:12288
    v_mfma_f32_16x16x32_bf16 v[140:143], a[12:15], v[92:95], v[140:143]
    ds_read_b64_tr_b16 v[78:79], v15 offset:12800
    s_lshl_b32 s24, s51, 6
    v_lshrrev_b32 v6, 1, v20
    v_add_u32 v6, s24, v6
    global_load_dwordx2 v[56:57], v6, s[96:97] offset:0
    global_load_dwordx2 v[58:59], v6, s[96:97] offset:32
    s_barrier
    s_waitcnt lgkmcnt(12)
    v_mfma_f32_16x16x32_bf16 v[112:115], a[16:19], v[96:99], v[112:115]
    ds_read_b64_tr_b16 v[80:81], v12 offset:16384
    v_mfma_f32_16x16x32_bf16 v[116:119], a[20:23], v[96:99], v[116:119]
    ds_read_b64_tr_b16 v[82:83], v12 offset:16896
    s_cmp_lg_u32 s40, 0
    s_cbranch_scc1 L_c_44
    s_add_u32 s37, s26, 16384
    s_add_u32 s36, s4, 16384
    buffer_load_dwordx4 a[192:195], v8, s[8:11], s37 offen offset:0 sc1
    buffer_load_dwordx4 a[196:199], v8, s[8:11], s37 offen offset:1024 sc1
    buffer_load_dwordx4 a[200:203], v8, s[8:11], s36 offen offset:0 sc1
    buffer_load_dwordx4 a[204:207], v8, s[8:11], s36 offen offset:1024 sc1
    s_add_u32 s37, s26, 20480
    s_add_u32 s36, s4, 20480
    buffer_load_dwordx4 a[208:211], v8, s[8:11], s37 offen offset:0 sc1
L_c_44:
    v_mfma_f32_16x16x32_bf16 v[120:123], a[16:19], v[100:103], v[120:123]
    ds_read_b64_tr_b16 v[84:85], v13 offset:16384
    v_mfma_f32_16x16x32_bf16 v[124:127], a[20:23], v[100:103], v[124:127]
    ds_read_b64_tr_b16 v[86:87], v13 offset:16896
    s_waitcnt lgkmcnt(12)
    v_mfma_f32_16x16x32_bf16 v[128:131], a[16:19], v[104:107], v[128:131]
    ds_read_b64_tr_b16 v[88:89], v14 offset:16384
    v_mfma_f32_16x16x32_bf16 v[132:135], a[20:23], v[104:107], v[132:135]
    ds_read_b64_tr_b16 v[90:91], v14 offset:16896
    v_mfma_f32_16x16x32_bf16 v[136:139], a[16:19], v[108:111], v[136:139]
    ds_read_b64_tr_b16 v[92:93], v15 offset:16384
    v_mfma_f32_16x16x32_bf16 v[140:143], a[20:23], v[108:111], v[140:143]
    ds_read_b64_tr_b16 v[94:95], v15 offset:16896
    s_waitcnt lgkmcnt(12)
    v_mfma_f32_16x16x32_bf16 v[112:115], a[24:27], v[64:67], v[112:115]
    ds_read_b64_tr_b16 v[96:97], v12 offset:20480
    v_mfma_f32_16x16x32_bf16 v[116:119], a[28:31], v[64:67], v[116:119]
    ds_read_b64_tr_b16 v[98:99], v12 offset:20992
    v_mfma_f32_16x16x32_bf16 v[120:123], a[24:27], v[68:71], v[120:123]
    ds_read_b64_tr_b16 v[100:101], v13 offset:20480
    v_mfma_f32_16x16x32_bf16 v[124:127], a[28:31], v[68:71], v[124:127]
    ds_read_b64_tr_b16 v[102:103], v13 offset:20992
    s_waitcnt lgkmcnt(12)
    v_mfma_f32_16x16x32_bf16 v[128:131], a[24:27], v[72:75], v[128:131]
    ds_read_b64_tr_b16 v[104:105], v14 offset:20480
    v_mfma_f32_16x16x32_bf16 v[132:135], a[28:31], v[72:75], v[132:135]
    ds_read_b64_tr_b16 v[106:107], v14 offset:20992
    v_mfma_f32_16x16x32_bf16 v[136:139], a[24:27], v[76:79], v[136:139]
    ds_read_b64_tr_b16 v[108:109], v15 offset:20480
    v_mfma_f32_16x16x32_bf16 v[140:143], a[28:31], v[76:79], v[140:143]
    ds_read_b64_tr_b16 v[110:111], v15 offset:20992
    s_waitcnt lgkmcnt(12)
    v_mfma_f32_16x16x32_bf16 v[112:115], a[32:35], v[80:83], v[112:115]
    ds_read_b64_tr_b16 v[64:65], v12 offset:24576
    v_mfma_f32_16x16x32_bf16 v[116:119], a[36:39], v[80:83], v[116:119]
    ds_read_b64_tr_b16 v[66:67], v12 offset:25088
    v_mfma_f32_16x16x32_bf16 v[120:123], a[32:35], v[84:87], v[120:123]
    ds_read_b64_tr_b16 v[68:69], v13 offset:24576
    v_mfma_f32_16x16x32_bf16 v[124:127], a[36:39], v[84:87], v[124:127]
    ds_read_b64_tr_b16 v[70:71], v13 offset:25088
    s_waitcnt lgkmcnt(12)
    v_mfma_f32_16x16x32_bf16 v[128:131], a[32:35], v[88:91], v[128:131]
    ds_read_b64_tr_b16 v[72:73], v14 offset:24576
    v_mfma_f32_16x16x32_bf16 v[132:135], a[36:39], v[88:91], v[132:135]
    ds_read_b64_tr_b16 v[74:75], v14 offset:25088
    v_mfma_f32_16x16x32_bf16 v[136:139], a[32:35], v[92:95], v[136:139]
    ds_read_b64_tr_b16 v[76:77], v15 offset:24576
    v_mfma_f32_16x16x32_bf16 v[140:143], a[36:39], v[92:95], v[140:143]
    ds_read_b64_tr_b16 v[78:79], v15 offset:25088
    s_waitcnt lgkmcnt(12)
    v_mfma_f32_16x16x32_bf16 v[112:115], a[40:43], v[96:99], v[112:115]
    ds_read_b64_tr_b16 v[80:81], v12 offset:28672
    v_mfma_f32_16x16x32_bf16 v[116:119], a[44:47], v[96:99], v[116:119]
    ds_read_b64_tr_b16 v[82:83], v12 offset:29184
    v_mfma_f32_16x16x32_bf16 v[120:123], a[40:43], v[100:103], v[120:123]
    ds_read_b64_tr_b16 v[84:85], v13 offset:28672
    v_mfma_f32_16x16x32_bf16 v[124:127], a[44:47], v[100:103], v[124:127]
    ds_read_b64_tr_b16 v[86:87], v13 offset:29184
    s_waitcnt lgkmcnt(12)
    v_mfma_f32_16x16x32_bf16 v[128:131], a[40:43], v[104:107], v[128:131]
    ds_read_b64_tr_b16 v[88:89], v14 offset:28672
    v_mfma_f32_16x16x32_bf16 v[132:135], a[44:47], v[104:107], v[132:135]
    ds_read_b64_tr_b16 v[90:91], v14 offset:29184
    v_mfma_f32_16x16x32_bf16 v[136:139], a[40:43], v[108:111], v[136:139]
    ds_read_b64_tr_b16 v[92:93], v15 offset:28672
    v_mfma_f32_16x16x32_bf16 v[140:143], a[44:47], v[108:111], v[140:143]
    ds_read_b64_tr_b16 v[94:95], v15 offset:29184
    s_cmp_lg_u32 s40, 0
    s_cbranch_scc1 L_w_45
    s_waitcnt vmcnt(22)
    s_branch L_w_46
L_w_45:
    s_waitcnt vmcnt(7)
L_w_46:
    s_barrier
    s_waitcnt lgkmcnt(12)
    v_mfma_f32_16x16x32_bf16 v[112:115], a[48:51], v[64:67], v[112:115]
    ds_read_b64_tr_b16 v[96:97], v12 offset:32768
    v_mfma_f32_16x16x32_bf16 v[116:119], a[52:55], v[64:67], v[116:119]
    ds_read_b64_tr_b16 v[98:99], v12 offset:33280
    s_cmp_lg_u32 s40, 0
    s_cbranch_scc1 L_c_47
    s_add_u32 s37, s26, 20480
    s_add_u32 s36, s4, 20480
    buffer_load_dwordx4 a[212:215], v8, s[8:11], s37 offen offset:1024 sc1
    buffer_load_dwordx4 a[216:219], v8, s[8:11], s36 offen offset:0 sc1
    buffer_load_dwordx4 a[220:223], v8, s[8:11], s36 offen offset:1024 sc1
    s_add_u32 s37, s26, 24576
    s_add_u32 s36, s4, 24576
    buffer_load_dwordx4 a[224:227], v8, s[8:11], s37 offen offset:0 sc1
    buffer_load_dwordx4 a[228:231], v8, s[8:11], s37 offen offset:1024 sc1
L_c_47:
    v_mfma_f32_16x16x32_bf16 v[120:123], a[48:51], v[68:71], v[120:123]
    ds_read_b64_tr_b16 v[100:101], v13 offset:32768
    v_mfma_f32_16x16x32_bf16 v[124:127], a[52:55], v[68:71], v[124:127]
    ds_read_b64_tr_b16 v[102:103], v13 offset:33280
    s_waitcnt lgkmcnt(12)
    v_mfma_f32_16x16x32_bf16 v[128:131], a[48:51], v[72:75], v[128:131]
    ds_read_b64_tr_b16 v[104:105], v14 offset:32768
    v_mfma_f32_16x16x32_bf16 v[132:135], a[52:55], v[72:75], v[132:135]
    ds_read_b64_tr_b16 v[106:107], v14 offset:33280
    v_mfma_f32_16x16x32_bf16 v[136:139], a[48:51], v[76:79], v[136:139]
    ds_read_b64_tr_b16 v[108:109], v15 offset:32768
    v_mfma_f32_16x16x32_bf16 v[140:143], a[52:55], v[76:79], v[140:143]
    ds_read_b64_tr_b16 v[110:111], v15 offset:33280
    s_waitcnt lgkmcnt(12)
    v_mfma_f32_16x16x32_bf16 v[112:115], a[56:59], v[80:83], v[112:115]
    ds_read_b64_tr_b16 v[64:65], v12 offset:36864
    v_mfma_f32_16x16x32_bf16 v[116:119], a[60:63], v[80:83], v[116:119]
    ds_read_b64_tr_b16 v[66:67], v12 offset:37376
    v_mfma_f32_16x16x32_bf16 v[120:123], a[56:59], v[84:87], v[120:123]
    ds_read_b64_tr_b16 v[68:69], v13 offset:36864
    v_mfma_f32_16x16x32_bf16 v[124:127], a[60:63], v[84:87], v[124:127]
    ds_read_b64_tr_b16 v[70:71], v13 offset:37376
    s_waitcnt lgkmcnt(12)
    v_mfma_f32_16x16x32_bf16 v[128:131], a[56:59], v[88:91], v[128:131]
    ds_read_b64_tr_b16 v[72:73], v14 offset:36864
    v_mfma_f32_16x16x32_bf16 v[132:135], a[60:63], v[88:91], v[132:135]
    ds_read_b64_tr_b16 v[74:75], v14 offset:37376
    v_mfma_f32_16x16x32_bf16 v[136:139], a[56:59], v[92:95], v[136:139]
    ds_read_b64_tr_b16 v[76:77], v15 offset:36864
    v_mfma_f32_16x16x32_bf16 v[140:143], a[60:63], v[92:95], v[140:143]
    ds_read_b64_tr_b16 v[78:79], v15 offset:37376
    s_waitcnt lgkmcnt(12)
    v_mfma_f32_16x16x32_bf16 v[112:115], a[64:67], v[96:99], v[112:115]
    ds_read_b64_tr_b16 v[80:81], v12 offset:40960
    v_mfma_f32_16x16x32_bf16 v[116:119], a[68:71], v[96:99], v[116:119]
    ds_read_b64_tr_b16 v[82:83], v12 offset:41472
    v_mfma_f32_16x16x32_bf16 v[120:123], a[64:67], v[100:103], v[120:123]
    ds_read_b64_tr_b16 v[84:85], v13 offset:40960
    v_mfma_f32_16x16x32_bf16 v[124:127], a[68:71], v[100:103], v[124:127]
    ds_read_b64_tr_b16 v[86:87], v13 offset:41472
    s_waitcnt lgkmcnt(12)
    v_mfma_f32_16x16x32_bf16 v[128:131], a[64:67], v[104:107], v[128:131]
    ds_read_b64_tr_b16 v[88:89], v14 offset:40960
    v_mfma_f32_16x16x32_bf16 v[132:135], a[68:71], v[104:107], v[132:135]
    ds_read_b64_tr_b16 v[90:91], v14 offset:41472
    v_mfma_f32_16x16x32_bf16 v[136:139], a[64:67], v[108:111], v[136:139]
    ds_read_b64_tr_b16 v[92:93], v15 offset:40960
    v_mfma_f32_16x16x32_bf16 v[140:143], a[68:71], v[108:111], v[140:143]
    ds_read_b64_tr_b16 v[94:95], v15 offset:41472
    s_waitcnt lgkmcnt(12)
    v_mfma_f32_16x16x32_bf16 v[112:115], a[72:75], v[64:67], v[112:115]
    ds_read_b64_tr_b16 v[96:97], v12 offset:45056
    v_mfma_f32_16x16x32_bf16 v[116:119], a[76:79], v[64:67], v[116:119]
    ds_read_b64_tr_b16 v[98:99], v12 offset:45568
    v_mfma_f32_16x16x32_bf16 v[120:123], a[72:75], v[68:71], v[120:123]
    ds_read_b64_tr_b16 v[100:101], v13 offset:45056
    v_mfma_f32_16x16x32_bf16 v[124:127], a[76:79], v[68:71], v[124:127]
    ds_read_b64_tr_b16 v[102:103], v13 offset:45568
    s_waitcnt lgkmcnt(12)
    v_mfma_f32_16x16x32_bf16 v[128:131], a[72:75], v[72:75], v[128:131]
    ds_read_b64_tr_b16 v[104:105], v14 offset:45056
    v_mfma_f32_16x16x32_bf16 v[132:135], a[76:79], v[72:75], v[132:135]
    ds_read_b64_tr_b16 v[106:107], v14 offset:45568
    v_mfma_f32_16x16x32_bf16 v[136:139], a[72:75], v[76:79], v[136:139]
    ds_read_b64_tr_b16 v[108:109], v15 offset:45056
    v_mfma_f32_16x16x32_bf16 v[140:143], a[76:79], v[76:79], v[140:143]
    ds_read_b64_tr_b16 v[110:111], v15 offset:45568
    s_cmp_lg_u32 s40, 0
    s_cbranch_scc1 L_w_48
    s_waitcnt vmcnt(23)
    s_branch L_w_49
L_w_48:
    s_waitcnt vmcnt(3)
L_w_49:
    s_barrier
    s_waitcnt lgkmcnt(12)
    v_mfma_f32_16x16x32_bf16 v[112:115], a[80:83], v[80:83], v[112:115]
    ds_read_b64_tr_b16 v[64:65], v12 offset:49152
    v_mfma_f32_16x16x32_bf16 v[116:119], a[84:87], v[80:83], v[116:119]
    ds_read_b64_tr_b16 v[66:67], v12 offset:49664
    s_cmp_lg_u32 s40, 0
    s_cbranch_scc1 L_c_50
    s_add_u32 s37, s26, 24576
    s_add_u32 s36, s4, 24576
    buffer_load_dwordx4 a[232:235], v8, s[8:11], s36 offen offset:0 sc1
    buffer_load_dwordx4 a[236:239], v8, s[8:11], s36 offen offset:1024 sc1
    s_add_u32 s37, s26, 28672
    s_add_u32 s36, s4, 28672
    buffer_load_dwordx4 a[240:243], v8, s[8:11], s37 offen offset:0 sc1
    buffer_load_dwordx4 a[244:247], v8, s[8:11], s37 offen offset:1024 sc1
    buffer_load_dwordx4 a[248:251], v8, s[8:11], s36 offen offset:0 sc1
L_c_50:
    v_mfma_f32_16x16x32_bf16 v[120:123], a[80:83], v[84:87], v[120:123]
    ds_read_b64_tr_b16 v[68:69], v13 offset:49152
    v_mfma_f32_16x16x32_bf16 v[124:127], a[84:87], v[84:87], v[124:127]
    ds_read_b64_tr_b16 v[70:71], v13 offset:49664
    s_waitcnt lgkmcnt(12)
    v_mfma_f32_16x16x32_bf16 v[128:131], a[80:83], v[88:91], v[128:131]
    ds_read_b64_tr_b16 v[72:73], v14 offset:49152
    v_mfma_f32_16x16x32_bf16 v[132:135], a[84:87], v[88:91], v[132:135]
    ds_read_b64_tr_b16 v[74:75], v14 offset:49664
    v_mfma_f32_16x16x32_bf16 v[136:139], a[80:83], v[92:95], v[136:139]
    ds_read_b64_tr_b16 v[76:77], v15 offset:49152
    v_mfma_f32_16x16x32_bf16 v[140:143], a[84:87], v[92:95], v[140:143]
    ds_read_b64_tr_b16 v[78:79], v15 offset:49664
    s_waitcnt lgkmcnt(12)
    v_mfma_f32_16x16x32_bf16 v[112:115], a[88:91], v[96:99], v[112:115]
    ds_read_b64_tr_b16 v[80:81], v12 offset:53248
    v_mfma_f32_16x16x32_bf16 v[116:119], a[92:95], v[96:99], v[116:119]
    ds_read_b64_tr_b16 v[82:83], v12 offset:53760
    s_add_u32 s47, s44, 0x8000
    s_or_b32 s18, s47, s7
    buffer_load_dword v4, v3, s[8:11], s18 offen sc1
    v_mfma_f32_16x16x32_bf16 v[120:123], a[88:91], v[100:103], v[120:123]
    ds_read_b64_tr_b16 v[84:85], v13 offset:53248
    v_mfma_f32_16x16x32_bf16 v[124:127], a[92:95], v[100:103], v[124:127]
    ds_read_b64_tr_b16 v[86:87], v13 offset:53760
    s_cmp_lg_u32 s40, 0
    s_cbranch_scc1 L_w_51
    s_waitcnt vmcnt(16)
    s_branch L_w_52
L_w_51:
    s_waitcnt vmcnt(1)
L_w_52:
    v_lshlrev_b32 v40, 16, v56
    v_and_b32 v41, 0xffff0000, v56
    v_lshlrev_b32 v42, 16, v57
    v_and_b32 v43, 0xffff0000, v57
    v_lshlrev_b32 v44, 16, v58
    v_and_b32 v45, 0xffff0000, v58
    v_lshlrev_b32 v46, 16, v59
    v_and_b32 v47, 0xffff0000, v59
    s_waitcnt lgkmcnt(12)
    v_mfma_f32_16x16x32_bf16 v[128:131], a[88:91], v[104:107], v[128:131]
    ds_read_b64_tr_b16 v[88:89], v14 offset:53248
    v_mfma_f32_16x16x32_bf16 v[132:135], a[92:95], v[104:107], v[132:135]
    ds_read_b64_tr_b16 v[90:91], v14 offset:53760
    v_mfma_f32_16x16x32_bf16 v[136:139], a[88:91], v[108:111], v[136:139]
    ds_read_b64_tr_b16 v[92:93], v15 offset:53248
    v_mfma_f32_16x16x32_bf16 v[140:143], a[92:95], v[108:111], v[140:143]
    ds_read_b64_tr_b16 v[94:95], v15 offset:53760
    s_waitcnt lgkmcnt(12)
    v_mfma_f32_16x16x32_bf16 v[112:115], a[96:99], v[64:67], v[112:115]
    ds_read_b64_tr_b16 v[96:97], v12 offset:57344
    v_mfma_f32_16x16x32_bf16 v[116:119], a[100:103], v[64:67], v[116:119]
    ds_read_b64_tr_b16 v[98:99], v12 offset:57856
    v_mfma_f32_16x16x32_bf16 v[120:123], a[96:99], v[68:71], v[120:123]
    ds_read_b64_tr_b16 v[100:101], v13 offset:57344
    v_mfma_f32_16x16x32_bf16 v[124:127], a[100:103], v[68:71], v[124:127]
    ds_read_b64_tr_b16 v[102:103], v13 offset:57856
    s_waitcnt lgkmcnt(12)
    v_mfma_f32_16x16x32_bf16 v[128:131], a[96:99], v[72:75], v[128:131]
    ds_read_b64_tr_b16 v[104:105], v14 offset:57344
    v_mfma_f32_16x16x32_bf16 v[132:135], a[100:103], v[72:75], v[132:135]
    ds_read_b64_tr_b16 v[106:107], v14 offset:57856
    s_lshl_b32 s23, s51, 11
    s_add_u32 s23, s23, s46
    s_mul_i32 s24, s50, 229376
    s_add_u32 s23, s23, s24
    s_add_u32 s23, s23, 0
    s_add_u32 s24, s23, 114688
    v_mfma_f32_16x16x32_bf16 v[136:139], a[96:99], v[76:79], v[136:139]
    ds_read_b64_tr_b16 v[108:109], v15 offset:57344
    v_mfma_f32_16x16x32_bf16 v[140:143], a[100:103], v[76:79], v[140:143]
    ds_read_b64_tr_b16 v[110:111], v15 offset:57856
    s_waitcnt lgkmcnt(12)
    v_mfma_f32_16x16x32_bf16 v[112:115], a[104:107], v[80:83], v[112:115]
    ds_read_b64_tr_b16 v[64:65], v12 offset:61440
    v_mfma_f32_16x16x32_bf16 v[116:119], a[108:111], v[80:83], v[116:119]
    ds_read_b64_tr_b16 v[66:67], v12 offset:61952
    s_cmp_lg_u32 s40, 0
    s_cbranch_scc1 L_c_53
    s_add_u32 s37, s26, 28672
    s_add_u32 s36, s4, 28672
    buffer_load_dwordx4 a[252:255], v8, s[8:11], s36 offen offset:1024 sc1
    s_add_u32 s37, s26, 32768
    s_add_u32 s36, s4, 32768
    buffer_load_dwordx4 v[160:163], v8, s[8:11], s37 offen offset:0 sc1
    buffer_load_dwordx4 v[164:167], v8, s[8:11], s37 offen offset:1024 sc1
    buffer_load_dwordx4 v[168:171], v8, s[8:11], s36 offen offset:0 sc1
    buffer_load_dwordx4 v[172:175], v8, s[8:11], s36 offen offset:1024 sc1
L_c_53:
    v_mfma_f32_16x16x32_bf16 v[120:123], a[104:107], v[84:87], v[120:123]
    ds_read_b64_tr_b16 v[68:69], v13 offset:61440
    v_mfma_f32_16x16x32_bf16 v[124:127], a[108:111], v[84:87], v[124:127]
    ds_read_b64_tr_b16 v[70:71], v13 offset:61952
    s_waitcnt lgkmcnt(12)
    v_mfma_f32_16x16x32_bf16 v[128:131], a[104:107], v[88:91], v[128:131]
    ds_read_b64_tr_b16 v[72:73], v14 offset:61440
    v_mfma_f32_16x16x32_bf16 v[132:135], a[108:111], v[88:91], v[132:135]
    ds_read_b64_tr_b16 v[74:75], v14 offset:61952
    s_lshl_b32 s30, s50, 9
    s_add_u32 s30, s30, s45
    buffer_load_dwordx2 v[24:25], v21, s[8:11], s30 offen offset:0 sc1
    buffer_load_dwordx2 v[26:27], v21, s[8:11], s30 offen offset:128 sc1
    buffer_load_dwordx2 v[28:29], v21, s[8:11], s30 offen offset:256 sc1
    buffer_load_dwordx2 v[30:31], v21, s[8:11], s30 offen offset:384 sc1
    v_mfma_f32_16x16x32_bf16 v[136:139], a[104:107], v[92:95], v[136:139]
    ds_read_b64_tr_b16 v[76:77], v15 offset:61440
    v_mfma_f32_16x16x32_bf16 v[140:143], a[108:111], v[92:95], v[140:143]
    ds_read_b64_tr_b16 v[78:79], v15 offset:61952
    s_waitcnt lgkmcnt(12)
    v_mfma_f32_16x16x32_bf16 v[112:115], a[112:115], v[96:99], v[112:115]
    v_mfma_f32_16x16x32_bf16 v[116:119], a[116:119], v[96:99], v[116:119]
    v_mfma_f32_16x16x32_bf16 v[120:123], a[112:115], v[100:103], v[120:123]
    v_mfma_f32_16x16x32_bf16 v[124:127], a[116:119], v[100:103], v[124:127]
    s_waitcnt lgkmcnt(8)
    v_mfma_f32_16x16x32_bf16 v[128:131], a[112:115], v[104:107], v[128:131]
    v_mfma_f32_16x16x32_bf16 v[132:135], a[116:119], v[104:107], v[132:135]
    v_mfma_f32_16x16x32_bf16 v[136:139], a[112:115], v[108:111], v[136:139]
    v_mfma_f32_16x16x32_bf16 v[140:143], a[116:119], v[108:111], v[140:143]
    s_waitcnt lgkmcnt(4)
    v_mfma_f32_16x16x32_bf16 v[112:115], a[120:123], v[64:67], v[112:115]
    v_mfma_f32_16x16x32_bf16 v[116:119], a[124:127], v[64:67], v[116:119]
    v_mfma_f32_16x16x32_bf16 v[120:123], a[120:123], v[68:71], v[120:123]
    v_mfma_f32_16x16x32_bf16 v[124:127], a[124:127], v[68:71], v[124:127]
    s_waitcnt lgkmcnt(0)
    v_mfma_f32_16x16x32_bf16 v[128:131], a[120:123], v[72:75], v[128:131]
    v_mfma_f32_16x16x32_bf16 v[132:135], a[124:127], v[72:75], v[132:135]
    v_mfma_f32_16x16x32_bf16 v[136:139], a[120:123], v[76:79], v[136:139]
    v_mfma_f32_16x16x32_bf16 v[140:143], a[124:127], v[76:79], v[140:143]
    s_cmp_lg_u32 s33, 1
    s_cbranch_scc1 L_spd_55
    s_cmp_lg_u32 s40, 0
    s_cbranch_scc1 L_w_56
    s_waitcnt vmcnt(9)
    s_branch L_w_57
L_w_56:
    s_waitcnt vmcnt(4)
L_w_57:
    v_cmp_le_u32 vcc, 16, v4
    s_nop 1
    s_cmp_eq_u64 vcc, -1
    s_cbranch_scc1 L_spd_55
    s_mov_b32 s18, 200000
    buffer_load_dword v4, v3, s[8:11], s47 offen sc1
    s_sleep 4
L_sp_54:
    buffer_load_dword v4, v3, s[8:11], s47 offen sc1
    s_waitcnt vmcnt(1)
    v_cmp_le_u32 vcc, 16, v4
    s_nop 1
    s_cmp_eq_u64 vcc, -1
    s_cbranch_scc1 L_spd_55
    s_sub_u32 s18, s18, 1
    s_cmp_lg_u32 s18, 0
    s_cbranch_scc1 L_sp_54
L_spd_55:
    s_barrier
    s_lshl_b32 s20, s50, 16
    s_add_u32 s20, s20, s43
    s_add_u32 s20, s20, s21
    s_add_u32 s20, s20, 1048576
    s_cmp_ge_u32 s17, 28
    s_cselect_b32 s20, 0x7f000000, s20
    s_add_u32 m0, s21, 98304
    s_add_u32 s22, s20, 0
    buffer_load_dwordx4 v9, s[8:11], s22 offen offset:0 sc1 lds
    buffer_load_dwordx4 v10, s[8:11], s22 offen offset:1024 sc1 lds
    buffer_load_dwordx4 v9, s[8:11], s22 offen offset:2048 sc1 lds
    buffer_load_dwordx4 v10, s[8:11], s22 offen offset:3072 sc1 lds
    s_mov_b32 s18, 200000
    s_waitcnt vmcnt(4)
L_rs_58:
    v_min3_u32 v6, v24, v26, v28
    v_min_u32 v6, v6, v30
    v_cmp_ne_u32 vcc, 0, v6
    s_nop 1
    s_cmp_eq_u64 vcc, -1
    s_cbranch_scc1 L_rsd_59
    s_sleep 1
    buffer_load_dwordx2 v[24:25], v21, s[8:11], s30 offen offset:0 sc1
    buffer_load_dwordx2 v[26:27], v21, s[8:11], s30 offen offset:128 sc1
    buffer_load_dwordx2 v[28:29], v21, s[8:11], s30 offen offset:256 sc1
    buffer_load_dwordx2 v[30:31], v21, s[8:11], s30 offen offset:384 sc1
    s_waitcnt vmcnt(0)
    s_sub_u32 s18, s18, 1
    s_cmp_lg_u32 s18, 0
    s_cbranch_scc1 L_rs_58
L_rsd_59:
    v_pk_fma_f32 v[48:49], v[32:33], v[24:25], v[40:41] op_sel:[0,1,0] op_sel_hi:[1,1,1] neg_lo:[0,1,0] neg_hi:[0,1,0]
    v_pk_fma_f32 v[50:51], v[34:35], v[24:25], v[42:43] op_sel:[0,1,0] op_sel_hi:[1,1,1] neg_lo:[0,1,0] neg_hi:[0,1,0]
    v_pk_fma_f32 v[52:53], v[36:37], v[24:25], v[44:45] op_sel:[0,1,0] op_sel_hi:[1,1,1] neg_lo:[0,1,0] neg_hi:[0,1,0]
    v_pk_fma_f32 v[54:55], v[38:39], v[24:25], v[46:47] op_sel:[0,1,0] op_sel_hi:[1,1,1] neg_lo:[0,1,0] neg_hi:[0,1,0]
    v_pk_fma_f32 v[56:57], v[32:33], v[26:27], v[40:41] op_sel:[0,1,0] op_sel_hi:[1,1,1] neg_lo:[0,1,0] neg_hi:[0,1,0]
    v_pk_fma_f32 v[58:59], v[34:35], v[26:27], v[42:43] op_sel:[0,1,0] op_sel_hi:[1,1,1] neg_lo:[0,1,0] neg_hi:[0,1,0]
    v_pk_fma_f32 v[60:61], v[36:37], v[26:27], v[44:45] op_sel:[0,1,0] op_sel_hi:[1,1,1] neg_lo:[0,1,0] neg_hi:[0,1,0]
    v_pk_fma_f32 v[62:63], v[38:39], v[26:27], v[46:47] op_sel:[0,1,0] op_sel_hi:[1,1,1] neg_lo:[0,1,0] neg_hi:[0,1,0]
    s_add_u32 m0, s21, 114688
    s_add_u32 s22, s20, 16384
    buffer_load_dwordx4 v9, s[8:11], s22 offen offset:0 sc1 lds
    buffer_load_dwordx4 v10, s[8:11], s22 offen offset:1024 sc1 lds
    v_pk_fma_f32 v[112:113], v[112:113], v[24:25], v[48:49] op_sel_hi:[1,0,1]
    v_pk_fma_f32 v[114:115], v[114:115], v[24:25], v[50:51] op_sel_hi:[1,0,1]
    v_pk_fma_f32 v[116:117], v[116:117], v[24:25], v[52:53] op_sel_hi:[1,0,1]
    v_pk_fma_f32 v[118:119], v[118:119], v[24:25], v[54:55] op_sel_hi:[1,0,1]
    v_pk_fma_f32 v[120:121], v[120:121], v[26:27], v[56:57] op_sel_hi:[1,0,1]
    v_pk_fma_f32 v[122:123], v[122:123], v[26:27], v[58:59] op_sel_hi:[1,0,1]
    v_pk_fma_f32 v[124:125], v[124:125], v[26:27], v[60:61] op_sel_hi:[1,0,1]
    v_pk_fma_f32 v[126:127], v[126:127], v[26:27], v[62:63] op_sel_hi:[1,0,1]
    buffer_load_dwordx4 v9, s[8:11], s22 offen offset:2048 sc1 lds
    buffer_load_dwordx4 v10, s[8:11], s22 offen offset:3072 sc1 lds
    v_max_f32 v112, 0, v112
    v_max_f32 v113, 0, v113
    v_max_f32 v114, 0, v114
    v_max_f32 v115, 0, v115
    v_max_f32 v116, 0, v116
    v_max_f32 v117, 0, v117
    v_max_f32 v118, 0, v118
    v_max_f32 v119, 0, v119
    s_add_u32 m0, s21, 131072
    s_add_u32 s22, s20, 32768
    buffer_load_dwordx4 v9, s[8:11], s22 offen offset:0 sc1 lds
    buffer_load_dwordx4 v10, s[8:11], s22 offen offset:1024 sc1 lds
    v_max_f32 v120, 0, v120
    v_max_f32 v121, 0, v121
    v_max_f32 v122, 0, v122
    v_max_f32 v123, 0, v123
    v_max_f32 v124, 0, v124
    v_max_f32 v125, 0, v125
    v_max_f32 v126, 0, v126
    v_max_f32 v127, 0, v127
    buffer_load_dwordx4 v9, s[8:11], s22 offen offset:2048 sc1 lds
    buffer_load_dwordx4 v10, s[8:11], s22 offen offset:3072 sc1 lds
    v_pk_mul_f32 v[112:113], v[112:113], v[112:113]
    v_pk_mul_f32 v[114:115], v[114:115], v[114:115]
    v_pk_mul_f32 v[116:117], v[116:117], v[116:117]
    v_pk_mul_f32 v[118:119], v[118:119], v[118:119]
    v_pk_mul_f32 v[120:121], v[120:121], v[120:121]
    v_pk_mul_f32 v[122:123], v[122:123], v[122:123]
    v_pk_mul_f32 v[124:125], v[124:125], v[124:125]
    v_pk_mul_f32 v[126:127], v[126:127], v[126:127]
    s_add_u32 m0, s21, 147456
    s_add_u32 s22, s20, 49152
    buffer_load_dwordx4 v9, s[8:11], s22 offen offset:0 sc1 lds
    buffer_load_dwordx4 v10, s[8:11], s22 offen offset:1024 sc1 lds
    v_cvt_pk_bf16_f32 v144, v112, v113
    v_cvt_pk_bf16_f32 v145, v114, v115
    v_cvt_pk_bf16_f32 v146, v116, v117
    v_cvt_pk_bf16_f32 v147, v118, v119
    buffer_store_dwordx4 v[144:147], v8, s[8:11], s23 offen offset:0 sc1
    v_cvt_pk_bf16_f32 v148, v120, v121
    v_cvt_pk_bf16_f32 v149, v122, v123
    v_cvt_pk_bf16_f32 v150, v124, v125
    v_cvt_pk_bf16_f32 v151, v126, v127
    buffer_store_dwordx4 v[148:151], v8, s[8:11], s23 offen offset:1024 sc1
    v_pk_fma_f32 v[48:49], v[32:33], v[28:29], v[40:41] op_sel:[0,1,0] op_sel_hi:[1,1,1] neg_lo:[0,1,0] neg_hi:[0,1,0]
    v_pk_fma_f32 v[50:51], v[34:35], v[28:29], v[42:43] op_sel:[0,1,0] op_sel_hi:[1,1,1] neg_lo:[0,1,0] neg_hi:[0,1,0]
    v_pk_fma_f32 v[52:53], v[36:37], v[28:29], v[44:45] op_sel:[0,1,0] op_sel_hi:[1,1,1] neg_lo:[0,1,0] neg_hi:[0,1,0]
    v_pk_fma_f32 v[54:55], v[38:39], v[28:29], v[46:47] op_sel:[0,1,0] op_sel_hi:[1,1,1] neg_lo:[0,1,0] neg_hi:[0,1,0]
    v_pk_fma_f32 v[56:57], v[32:33], v[30:31], v[40:41] op_sel:[0,1,0] op_sel_hi:[1,1,1] neg_lo:[0,1,0] neg_hi:[0,1,0]
    v_pk_fma_f32 v[58:59], v[34:35], v[30:31], v[42:43] op_sel:[0,1,0] op_sel_hi:[1,1,1] neg_lo:[0,1,0] neg_hi:[0,1,0]
    v_pk_fma_f32 v[60:61], v[36:37], v[30:31], v[44:45] op_sel:[0,1,0] op_sel_hi:[1,1,1] neg_lo:[0,1,0] neg_hi:[0,1,0]
    v_pk_fma_f32 v[62:63], v[38:39], v[30:31], v[46:47] op_sel:[0,1,0] op_sel_hi:[1,1,1] neg_lo:[0,1,0] neg_hi:[0,1,0]
    v_pk_fma_f32 v[128:129], v[128:129], v[28:29], v[48:49] op_sel_hi:[1,0,1]
    v_pk_fma_f32 v[130:131], v[130:131], v[28:29], v[50:51] op_sel_hi:[1,0,1]
    v_pk_fma_f32 v[132:133], v[132:133], v[28:29], v[52:53] op_sel_hi:[1,0,1]
    v_pk_fma_f32 v[134:135], v[134:135], v[28:29], v[54:55] op_sel_hi:[1,0,1]
    v_pk_fma_f32 v[136:137], v[136:137], v[30:31], v[56:57] op_sel_hi:[1,0,1]
    v_pk_fma_f32 v[138:139], v[138:139], v[30:31], v[58:59] op_sel_hi:[1,0,1]
    v_pk_fma_f32 v[140:141], v[140:141], v[30:31], v[60:61] op_sel_hi:[1,0,1]
    v_pk_fma_f32 v[142:143], v[142:143], v[30:31], v[62:63] op_sel_hi:[1,0,1]
    v_max_f32 v128, 0, v128
    v_max_f32 v129, 0, v129
    v_max_f32 v130, 0, v130
    v_max_f32 v131, 0, v131
    v_max_f32 v132, 0, v132
    v_max_f32 v133, 0, v133
    v_max_f32 v134, 0, v134
    v_max_f32 v135, 0, v135
    v_max_f32 v136, 0, v136
    v_max_f32 v137, 0, v137
    v_max_f32 v138, 0, v138
    v_max_f32 v139, 0, v139
    v_max_f32 v140, 0, v140
    v_max_f32 v141, 0, v141
    v_max_f32 v142, 0, v142
    v_max_f32 v143, 0, v143
    v_pk_mul_f32 v[128:129], v[128:129], v[128:129]
    v_pk_mul_f32 v[130:131], v[130:131], v[130:131]
    v_pk_mul_f32 v[132:133], v[132:133], v[132:133]
    v_pk_mul_f32 v[134:135], v[134:135], v[134:135]
    v_pk_mul_f32 v[136:137], v[136:137], v[136:137]
    v_pk_mul_f32 v[138:139], v[138:139], v[138:139]
    v_pk_mul_f32 v[140:141], v[140:141], v[140:141]
    v_pk_mul_f32 v[142:143], v[142:143], v[142:143]
    v_cvt_pk_bf16_f32 v152, v128, v129
    v_cvt_pk_bf16_f32 v153, v130, v131
    v_cvt_pk_bf16_f32 v154, v132, v133
    v_cvt_pk_bf16_f32 v155, v134, v135
    buffer_store_dwordx4 v[152:155], v8, s[8:11], s24 offen offset:0 sc1
    v_cvt_pk_bf16_f32 v156, v136, v137
    v_cvt_pk_bf16_f32 v157, v138, v139
    v_cvt_pk_bf16_f32 v158, v140, v141
    v_cvt_pk_bf16_f32 v159, v142, v143
    buffer_store_dwordx4 v[156:159], v8, s[8:11], s24 offen offset:1024 sc1
    buffer_load_dwordx4 v9, s[8:11], s22 offen offset:2048 sc1 lds
    buffer_load_dwordx4 v10, s[8:11], s22 offen offset:3072 sc1 lds
    s_waitcnt vmcnt(16)
    s_barrier
    ds_read_b64_tr_b16 v[64:65], v12 offset:0
    ds_read_b64_tr_b16 v[66:67], v12 offset:512
    ds_read_b64_tr_b16 v[68:69], v13 offset:0
    ds_read_b64_tr_b16 v[70:71], v13 offset:512
    ds_read_b64_tr_b16 v[72:73], v14 offset:0
    ds_read_b64_tr_b16 v[74:75], v14 offset:512
    ds_read_b64_tr_b16 v[76:77], v15 offset:0
    ds_read_b64_tr_b16 v[78:79], v15 offset:512
    ds_read_b64_tr_b16 v[80:81], v12 offset:4096
    ds_read_b64_tr_b16 v[82:83], v12 offset:4608
    ds_read_b64_tr_b16 v[84:85], v13 offset:4096
    ds_read_b64_tr_b16 v[86:87], v13 offset:4608
    ds_read_b64_tr_b16 v[88:89], v14 offset:4096
    ds_read_b64_tr_b16 v[90:91], v14 offset:4608
    ds_read_b64_tr_b16 v[92:93], v15 offset:4096
    ds_read_b64_tr_b16 v[94:95], v15 offset:4608
    s_waitcnt lgkmcnt(12)
    v_mfma_f32_16x16x32_bf16 v[112:115], a[0:3], v[64:67], 0
    ds_read_b64_tr_b16 v[96:97], v12 offset:8192
    v_mfma_f32_16x16x32_bf16 v[116:119], a[4:7], v[64:67], 0
    ds_read_b64_tr_b16 v[98:99], v12 offset:8704
    v_mfma_f32_16x16x32_bf16 v[120:123], a[0:3], v[68:71], 0
    ds_read_b64_tr_b16 v[100:101], v13 offset:8192
    v_mfma_f32_16x16x32_bf16 v[124:127], a[4:7], v[68:71], 0
    ds_read_b64_tr_b16 v[102:103], v13 offset:8704
    s_waitcnt lgkmcnt(12)
    v_mfma_f32_16x16x32_bf16 v[128:131], a[0:3], v[72:75], 0
    ds_read_b64_tr_b16 v[104:105], v14 offset:8192
    v_mfma_f32_16x16x32_bf16 v[132:135], a[4:7], v[72:75], 0
    ds_read_b64_tr_b16 v[106:107], v14 offset:8704
    v_mfma_f32_16x16x32_bf16 v[136:139], a[0:3], v[76:79], 0
    ds_read_b64_tr_b16 v[108:109], v15 offset:8192
    v_mfma_f32_16x16x32_bf16 v[140:143], a[4:7], v[76:79], 0
    ds_read_b64_tr_b16 v[110:111], v15 offset:8704
    s_waitcnt lgkmcnt(12)
    v_mfma_f32_16x16x32_bf16 v[112:115], a[8:11], v[80:83], v[112:115]
    ds_read_b64_tr_b16 v[64:65], v12 offset:12288
    v_mfma_f32_16x16x32_bf16 v[116:119], a[12:15], v[80:83], v[116:119]
    ds_read_b64_tr_b16 v[66:67], v12 offset:12800
    v_mfma_f32_16x16x32_bf16 v[120:123], a[8:11], v[84:87], v[120:123]
    ds_read_b64_tr_b16 v[68:69], v13 offset:12288
    v_mfma_f32_16x16x32_bf16 v[124:127], a[12:15], v[84:87], v[124:127]
    ds_read_b64_tr_b16 v[70:71], v13 offset:12800
    s_waitcnt lgkmcnt(12)
    v_mfma_f32_16x16x32_bf16 v[128:131], a[8:11], v[88:91], v[128:131]
    ds_read_b64_tr_b16 v[72:73], v14 offset:12288
    v_mfma_f32_16x16x32_bf16 v[132:135], a[12:15], v[88:91], v[132:135]
    ds_read_b64_tr_b16 v[74:75], v14 offset:12800
    v_mfma_f32_16x16x32_bf16 v[136:139], a[8:11], v[92:95], v[136:139]
    ds_read_b64_tr_b16 v[76:77], v15 offset:12288
    v_mfma_f32_16x16x32_bf16 v[140:143], a[12:15], v[92:95], v[140:143]
    ds_read_b64_tr_b16 v[78:79], v15 offset:12800
    s_waitcnt vmcnt(12)
    s_barrier
    s_waitcnt lgkmcnt(12)
    v_mfma_f32_16x16x32_bf16 v[112:115], a[16:19], v[96:99], v[112:115]
    ds_read_b64_tr_b16 v[80:81], v12 offset:16384
    v_mfma_f32_16x16x32_bf16 v[116:119], a[20:23], v[96:99], v[116:119]
    ds_read_b64_tr_b16 v[82:83], v12 offset:16896
    s_cmp_lg_u32 s40, 0
    s_cbranch_scc1 L_c_60
    s_add_u32 s37, s26, 36864
    s_add_u32 s36, s4, 36864
    buffer_load_dwordx4 v[176:179], v8, s[8:11], s37 offen offset:0 sc1
    buffer_load_dwordx4 v[180:183], v8, s[8:11], s37 offen offset:1024 sc1
    buffer_load_dwordx4 v[184:187], v8, s[8:11], s36 offen offset:0 sc1
    buffer_load_dwordx4 v[188:191], v8, s[8:11], s36 offen offset:1024 sc1
    s_add_u32 s37, s26, 40960
    s_add_u32 s36, s4, 40960
    buffer_load_dwordx4 v[192:195], v8, s[8:11], s37 offen offset:0 sc1
L_c_60:
    v_mfma_f32_16x16x32_bf16 v[120:123], a[16:19], v[100:103], v[120:123]
    ds_read_b64_tr_b16 v[84:85], v13 offset:16384
    v_mfma_f32_16x16x32_bf16 v[124:127], a[20:23], v[100:103], v[124:127]
    ds_read_b64_tr_b16 v[86:87], v13 offset:16896
    s_waitcnt lgkmcnt(12)
    v_mfma_f32_16x16x32_bf16 v[128:131], a[16:19], v[104:107], v[128:131]
    ds_read_b64_tr_b16 v[88:89], v14 offset:16384
    v_mfma_f32_16x16x32_bf16 v[132:135], a[20:23], v[104:107], v[132:135]
    ds_read_b64_tr_b16 v[90:91], v14 offset:16896
    v_mfma_f32_16x16x32_bf16 v[136:139], a[16:19], v[108:111], v[136:139]
    ds_read_b64_tr_b16 v[92:93], v15 offset:16384
    v_mfma_f32_16x16x32_bf16 v[140:143], a[20:23], v[108:111], v[140:143]
    ds_read_b64_tr_b16 v[94:95], v15 offset:16896
    s_waitcnt lgkmcnt(12)
    v_mfma_f32_16x16x32_bf16 v[112:115], a[24:27], v[64:67], v[112:115]
    ds_read_b64_tr_b16 v[96:97], v12 offset:20480
    v_mfma_f32_16x16x32_bf16 v[116:119], a[28:31], v[64:67], v[116:119]
    ds_read_b64_tr_b16 v[98:99], v12 offset:20992
    v_mfma_f32_16x16x32_bf16 v[120:123], a[24:27], v[68:71], v[120:123]
    ds_read_b64_tr_b16 v[100:101], v13 offset:20480
    v_mfma_f32_16x16x32_bf16 v[124:127], a[28:31], v[68:71], v[124:127]
    ds_read_b64_tr_b16 v[102:103], v13 offset:20992
    s_waitcnt lgkmcnt(12)
    v_mfma_f32_16x16x32_bf16 v[128:131], a[24:27], v[72:75], v[128:131]
    ds_read_b64_tr_b16 v[104:105], v14 offset:20480
    v_mfma_f32_16x16x32_bf16 v[132:135], a[28:31], v[72:75], v[132:135]
    ds_read_b64_tr_b16 v[106:107], v14 offset:20992
    v_mfma_f32_16x16x32_bf16 v[136:139], a[24:27], v[76:79], v[136:139]
    ds_read_b64_tr_b16 v[108:109], v15 offset:20480
    v_mfma_f32_16x16x32_bf16 v[140:143], a[28:31], v[76:79], v[140:143]
    ds_read_b64_tr_b16 v[110:111], v15 offset:20992
    s_waitcnt lgkmcnt(12)
    v_mfma_f32_16x16x32_bf16 v[112:115], a[32:35], v[80:83], v[112:115]
    ds_read_b64_tr_b16 v[64:65], v12 offset:24576
    v_mfma_f32_16x16x32_bf16 v[116:119], a[36:39], v[80:83], v[116:119]
    ds_read_b64_tr_b16 v[66:67], v12 offset:25088
    v_mfma_f32_16x16x32_bf16 v[120:123], a[32:35], v[84:87], v[120:123]
    ds_read_b64_tr_b16 v[68:69], v13 offset:24576
    v_mfma_f32_16x16x32_bf16 v[124:127], a[36:39], v[84:87], v[124:127]
    ds_read_b64_tr_b16 v[70:71], v13 offset:25088
    s_waitcnt lgkmcnt(12)
    v_mfma_f32_16x16x32_bf16 v[128:131], a[32:35], v[88:91], v[128:131]
    ds_read_b64_tr_b16 v[72:73], v14 offset:24576
    v_mfma_f32_16x16x32_bf16 v[132:135], a[36:39], v[88:91], v[132:135]
    ds_read_b64_tr_b16 v[74:75], v14 offset:25088
    v_mfma_f32_16x16x32_bf16 v[136:139], a[32:35], v[92:95], v[136:139]
    ds_read_b64_tr_b16 v[76:77], v15 offset:24576
    v_mfma_f32_16x16x32_bf16 v[140:143], a[36:39], v[92:95], v[140:143]
    ds_read_b64_tr_b16 v[78:79], v15 offset:25088
    s_waitcnt lgkmcnt(12)
    v_mfma_f32_16x16x32_bf16 v[112:115], a[40:43], v[96:99], v[112:115]
    ds_read_b64_tr_b16 v[80:81], v12 offset:28672
    v_mfma_f32_16x16x32_bf16 v[116:119], a[44:47], v[96:99], v[116:119]
    ds_read_b64_tr_b16 v[82:83], v12 offset:29184
    v_mfma_f32_16x16x32_bf16 v[120:123], a[40:43], v[100:103], v[120:123]
    ds_read_b64_tr_b16 v[84:85], v13 offset:28672
    v_mfma_f32_16x16x32_bf16 v[124:127], a[44:47], v[100:103], v[124:127]
    ds_read_b64_tr_b16 v[86:87], v13 offset:29184
    s_waitcnt lgkmcnt(12)
    v_mfma_f32_16x16x32_bf16 v[128:131], a[40:43], v[104:107], v[128:131]
    ds_read_b64_tr_b16 v[88:89], v14 offset:28672
    v_mfma_f32_16x16x32_bf16 v[132:135], a[44:47], v[104:107], v[132:135]
    ds_read_b64_tr_b16 v[90:91], v14 offset:29184
    v_mfma_f32_16x16x32_bf16 v[136:139], a[40:43], v[108:111], v[136:139]
    ds_read_b64_tr_b16 v[92:93], v15 offset:28672
    v_mfma_f32_16x16x32_bf16 v[140:143], a[44:47], v[108:111], v[140:143]
    ds_read_b64_tr_b16 v[94:95], v15 offset:29184
    s_lshl_b32 s3, s50, 11
    s_add_u32 s3, s3, s44
    s_add_u32 s3, s3, 0x10000
    s_or_b32 s3, s3, s6
    s_cmp_lg_u32 s40, 0
    s_cbranch_scc1 L_w_61
    s_waitcnt vmcnt(7)
    s_branch L_w_62
L_w_61:
    s_waitcnt vmcnt(2)
L_w_62:
    s_barrier
    s_mov_b64 exec, 1
    buffer_atomic_add v5, v2, s[8:11], s3 offen sc1
    s_mov_b64 exec, -1
    s_barrier
    s_waitcnt lgkmcnt(12)
    v_mfma_f32_16x16x32_bf16 v[112:115], a[48:51], v[64:67], v[112:115]
    ds_read_b64_tr_b16 v[96:97], v12 offset:32768
    v_mfma_f32_16x16x32_bf16 v[116:119], a[52:55], v[64:67], v[116:119]
    ds_read_b64_tr_b16 v[98:99], v12 offset:33280
    s_cmp_lg_u32 s40, 0
    s_cbranch_scc1 L_c_63
    s_add_u32 s37, s26, 40960
    s_add_u32 s36, s4, 40960
    buffer_load_dwordx4 v[196:199], v8, s[8:11], s37 offen offset:1024 sc1
    buffer_load_dwordx4 v[200:203], v8, s[8:11], s36 offen offset:0 sc1
    buffer_load_dwordx4 v[204:207], v8, s[8:11], s36 offen offset:1024 sc1
    s_add_u32 s37, s26, 45056
    s_add_u32 s36, s4, 45056
    buffer_load_dwordx4 v[208:211], v8, s[8:11], s37 offen offset:0 sc1
    buffer_load_dwordx4 v[212:215], v8, s[8:11], s37 offen offset:1024 sc1
L_c_63:
    v_mfma_f32_16x16x32_bf16 v[120:123], a[48:51], v[68:71], v[120:123]
    ds_read_b64_tr_b16 v[100:101], v13 offset:32768
    v_mfma_f32_16x16x32_bf16 v[124:127], a[52:55], v[68:71], v[124:127]
    ds_read_b64_tr_b16 v[102:103], v13 offset:33280
    s_waitcnt lgkmcnt(12)
    v_mfma_f32_16x16x32_bf16 v[128:131], a[48:51], v[72:75], v[128:131]
    ds_read_b64_tr_b16 v[104:105], v14 offset:32768
    v_mfma_f32_16x16x32_bf16 v[132:135], a[52:55], v[72:75], v[132:135]
    ds_read_b64_tr_b16 v[106:107], v14 offset:33280
    v_mfma_f32_16x16x32_bf16 v[136:139], a[48:51], v[76:79], v[136:139]
    ds_read_b64_tr_b16 v[108:109], v15 offset:32768
    v_mfma_f32_16x16x32_bf16 v[140:143], a[52:55], v[76:79], v[140:143]
    ds_read_b64_tr_b16 v[110:111], v15 offset:33280
    s_waitcnt lgkmcnt(12)
    v_mfma_f32_16x16x32_bf16 v[112:115], a[56:59], v[80:83], v[112:115]
    ds_read_b64_tr_b16 v[64:65], v12 offset:36864
    v_mfma_f32_16x16x32_bf16 v[116:119], a[60:63], v[80:83], v[116:119]
    ds_read_b64_tr_b16 v[66:67], v12 offset:37376
    v_mfma_f32_16x16x32_bf16 v[120:123], a[56:59], v[84:87], v[120:123]
    ds_read_b64_tr_b16 v[68:69], v13 offset:36864
    v_mfma_f32_16x16x32_bf16 v[124:127], a[60:63], v[84:87], v[124:127]
    ds_read_b64_tr_b16 v[70:71], v13 offset:37376
    s_waitcnt lgkmcnt(12)
    v_mfma_f32_16x16x32_bf16 v[128:131], a[56:59], v[88:91], v[128:131]
    ds_read_b64_tr_b16 v[72:73], v14 offset:36864
    v_mfma_f32_16x16x32_bf16 v[132:135], a[60:63], v[88:91], v[132:135]
    ds_read_b64_tr_b16 v[74:75], v14 offset:37376
    v_mfma_f32_16x16x32_bf16 v[136:139], a[56:59], v[92:95], v[136:139]
    ds_read_b64_tr_b16 v[76:77], v15 offset:36864
    v_mfma_f32_16x16x32_bf16 v[140:143], a[60:63], v[92:95], v[140:143]
    ds_read_b64_tr_b16 v[78:79], v15 offset:37376
    s_waitcnt lgkmcnt(12)
    v_mfma_f32_16x16x32_bf16 v[112:115], a[64:67], v[96:99], v[112:115]
    ds_read_b64_tr_b16 v[80:81], v12 offset:40960
    v_mfma_f32_16x16x32_bf16 v[116:119], a[68:71], v[96:99], v[116:119]
    ds_read_b64_tr_b16 v[82:83], v12 offset:41472
    v_mfma_f32_16x16x32_bf16 v[120:123], a[64:67], v[100:103], v[120:123]
    ds_read_b64_tr_b16 v[84:85], v13 offset:40960
    v_mfma_f32_16x16x32_bf16 v[124:127], a[68:71], v[100:103], v[124:127]
    ds_read_b64_tr_b16 v[86:87], v13 offset:41472
    s_waitcnt lgkmcnt(12)
    v_mfma_f32_16x16x32_bf16 v[128:131], a[64:67], v[104:107], v[128:131]
    ds_read_b64_tr_b16 v[88:89], v14 offset:40960
    v_mfma_f32_16x16x32_bf16 v[132:135], a[68:71], v[104:107], v[132:135]
    ds_read_b64_tr_b16 v[90:91], v14 offset:41472
    v_lshrrev_b32 v22, 2, v1
    v_lshlrev_b32 v22, 7, v22
    v_and_b32 v23, 3, v1
    v_lshl_add_u32 v22, v23, 4, v22
    s_lshl_b32 s18, s53, 13
    s_lshr_b32 s19, s52, 1
    s_lshl_b32 s19, s19, 16
    s_add_u32 s18, s18, s19
    s_and_b32 s19, s52, 1
    s_lshl_b32 s19, s19, 6
    s_add_u32 s18, s18, s19
    s_lshl_b32 s19, s33, 11
    s_add_u32 s18, s18, s19
    s_add_u32 s18, s18, s43
    s_lshl_b32 s19, s33, 10
    s_add_u32 m0, s19, 75776
    s_nop 0
    buffer_load_dwordx4 v22, s[8:11], s18 offen sc1 lds
    s_add_u32 m0, s19, 79872
    s_add_u32 s18, s18, 1048576
    buffer_load_dwordx4 v22, s[8:11], s18 offen sc1 lds
    v_mfma_f32_16x16x32_bf16 v[136:139], a[64:67], v[108:111], v[136:139]
    ds_read_b64_tr_b16 v[92:93], v15 offset:40960
    v_mfma_f32_16x16x32_bf16 v[140:143], a[68:71], v[108:111], v[140:143]
    ds_read_b64_tr_b16 v[94:95], v15 offset:41472
    s_waitcnt lgkmcnt(12)
    v_mfma_f32_16x16x32_bf16 v[112:115], a[72:75], v[64:67], v[112:115]
    ds_read_b64_tr_b16 v[96:97], v12 offset:45056
    v_mfma_f32_16x16x32_bf16 v[116:119], a[76:79], v[64:67], v[116:119]
    ds_read_b64_tr_b16 v[98:99], v12 offset:45568
    v_mfma_f32_16x16x32_bf16 v[120:123], a[72:75], v[68:71], v[120:123]
    ds_read_b64_tr_b16 v[100:101], v13 offset:45056
    v_mfma_f32_16x16x32_bf16 v[124:127], a[76:79], v[68:71], v[124:127]
    ds_read_b64_tr_b16 v[102:103], v13 offset:45568
    s_waitcnt lgkmcnt(12)
    v_mfma_f32_16x16x32_bf16 v[128:131], a[72:75], v[72:75], v[128:131]
    ds_read_b64_tr_b16 v[104:105], v14 offset:45056
    v_mfma_f32_16x16x32_bf16 v[132:135], a[76:79], v[72:75], v[132:135]
    ds_read_b64_tr_b16 v[106:107], v14 offset:45568
    v_mfma_f32_16x16x32_bf16 v[136:139], a[72:75], v[76:79], v[136:139]
    ds_read_b64_tr_b16 v[108:109], v15 offset:45056
    v_mfma_f32_16x16x32_bf16 v[140:143], a[76:79], v[76:79], v[140:143]
    ds_read_b64_tr_b16 v[110:111], v15 offset:45568
    s_cmp_lg_u32 s40, 0
    s_cbranch_scc1 L_w_64
    s_waitcnt vmcnt(13)
    s_branch L_w_65
L_w_64:
    s_waitcnt vmcnt(3)
L_w_65:
    s_barrier
    s_waitcnt lgkmcnt(12)
    v_mfma_f32_16x16x32_bf16 v[112:115], a[80:83], v[80:83], v[112:115]
    ds_read_b64_tr_b16 v[64:65], v12 offset:49152
    v_mfma_f32_16x16x32_bf16 v[116:119], a[84:87], v[80:83], v[116:119]
    ds_read_b64_tr_b16 v[66:67], v12 offset:49664
    s_cmp_lg_u32 s40, 0
    s_cbranch_scc1 L_c_66
    s_add_u32 s37, s26, 45056
    s_add_u32 s36, s4, 45056
    buffer_load_dwordx4 v[216:219], v8, s[8:11], s36 offen offset:0 sc1
    buffer_load_dwordx4 v[220:223], v8, s[8:11], s36 offen offset:1024 sc1
    s_add_u32 s37, s26, 49152
    s_add_u32 s36, s4, 49152
    buffer_load_dwordx4 v[224:227], v8, s[8:11], s37 offen offset:0 sc1
    buffer_load_dwordx4 v[228:231], v8, s[8:11], s37 offen offset:1024 sc1
    buffer_load_dwordx4 v[232:235], v8, s[8:11], s36 offen offset:0 sc1
L_c_66:
    v_mfma_f32_16x16x32_bf16 v[120:123], a[80:83], v[84:87], v[120:123]
    ds_read_b64_tr_b16 v[68:69], v13 offset:49152
    v_mfma_f32_16x16x32_bf16 v[124:127], a[84:87], v[84:87], v[124:127]
    ds_read_b64_tr_b16 v[70:71], v13 offset:49664
    s_waitcnt lgkmcnt(12)
    v_mfma_f32_16x16x32_bf16 v[128:131], a[80:83], v[88:91], v[128:131]
    ds_read_b64_tr_b16 v[72:73], v14 offset:49152
    v_mfma_f32_16x16x32_bf16 v[132:135], a[84:87], v[88:91], v[132:135]
    ds_read_b64_tr_b16 v[74:75], v14 offset:49664
    v_mfma_f32_16x16x32_bf16 v[136:139], a[80:83], v[92:95], v[136:139]
    ds_read_b64_tr_b16 v[76:77], v15 offset:49152
    v_mfma_f32_16x16x32_bf16 v[140:143], a[84:87], v[92:95], v[140:143]
    ds_read_b64_tr_b16 v[78:79], v15 offset:49664
    s_waitcnt lgkmcnt(12)
    v_mfma_f32_16x16x32_bf16 v[112:115], a[88:91], v[96:99], v[112:115]
    ds_read_b64_tr_b16 v[80:81], v12 offset:53248
    v_mfma_f32_16x16x32_bf16 v[116:119], a[92:95], v[96:99], v[116:119]
    ds_read_b64_tr_b16 v[82:83], v12 offset:53760
    v_mfma_f32_16x16x32_bf16 v[120:123], a[88:91], v[100:103], v[120:123]
    ds_read_b64_tr_b16 v[84:85], v13 offset:53248
    v_mfma_f32_16x16x32_bf16 v[124:127], a[92:95], v[100:103], v[124:127]
    ds_read_b64_tr_b16 v[86:87], v13 offset:53760
    s_waitcnt lgkmcnt(12)
    v_mfma_f32_16x16x32_bf16 v[128:131], a[88:91], v[104:107], v[128:131]
    ds_read_b64_tr_b16 v[88:89], v14 offset:53248
    v_mfma_f32_16x16x32_bf16 v[132:135], a[92:95], v[104:107], v[132:135]
    ds_read_b64_tr_b16 v[90:91], v14 offset:53760
    v_mfma_f32_16x16x32_bf16 v[136:139], a[88:91], v[108:111], v[136:139]
    ds_read_b64_tr_b16 v[92:93], v15 offset:53248
    v_mfma_f32_16x16x32_bf16 v[140:143], a[92:95], v[108:111], v[140:143]
    ds_read_b64_tr_b16 v[94:95], v15 offset:53760
    s_waitcnt lgkmcnt(12)
    v_mfma_f32_16x16x32_bf16 v[112:115], a[96:99], v[64:67], v[112:115]
    ds_read_b64_tr_b16 v[96:97], v12 offset:57344
    v_mfma_f32_16x16x32_bf16 v[116:119], a[100:103], v[64:67], v[116:119]
    ds_read_b64_tr_b16 v[98:99], v12 offset:57856
    v_mfma_f32_16x16x32_bf16 v[120:123], a[96:99], v[68:71], v[120:123]
    ds_read_b64_tr_b16 v[100:101], v13 offset:57344
    v_mfma_f32_16x16x32_bf16 v[124:127], a[100:103], v[68:71], v[124:127]
    ds_read_b64_tr_b16 v[102:103], v13 offset:57856
    s_waitcnt lgkmcnt(12)
    v_mfma_f32_16x16x32_bf16 v[128:131], a[96:99], v[72:75], v[128:131]
    ds_read_b64_tr_b16 v[104:105], v14 offset:57344
    v_mfma_f32_16x16x32_bf16 v[132:135], a[100:103], v[72:75], v[132:135]
    ds_read_b64_tr_b16 v[106:107], v14 offset:57856
    s_lshl_b32 s23, s51, 11
    s_add_u32 s23, s23, s46
    s_mul_i32 s24, s50, 229376
    s_add_u32 s23, s23, s24
    s_add_u32 s23, s23, 3670016
    s_add_u32 s24, s23, 114688
    v_mfma_f32_16x16x32_bf16 v[136:139], a[96:99], v[76:79], v[136:139]
    ds_read_b64_tr_b16 v[108:109], v15 offset:57344
    v_mfma_f32_16x16x32_bf16 v[140:143], a[100:103], v[76:79], v[140:143]
    ds_read_b64_tr_b16 v[110:111], v15 offset:57856
    s_lshr_b32 s47, s52, 1
    s_lshl_b32 s47, s47, 11
    s_add_u32 s47, s47, s44
    s_add_u32 s47, s47, 0x10000
    s_or_b32 s18, s47, s7
    buffer_load_dword v4, v2, s[8:11], s18 offen sc1
    s_waitcnt lgkmcnt(12)
    v_mfma_f32_16x16x32_bf16 v[112:115], a[104:107], v[80:83], v[112:115]
    ds_read_b64_tr_b16 v[64:65], v12 offset:61440
    v_mfma_f32_16x16x32_bf16 v[116:119], a[108:111], v[80:83], v[116:119]
    ds_read_b64_tr_b16 v[66:67], v12 offset:61952
    s_cmp_lg_u32 s40, 0
    s_cbranch_scc1 L_c_67
    s_add_u32 s37, s26, 49152
    s_add_u32 s36, s4, 49152
    buffer_load_dwordx4 v[236:239], v8, s[8:11], s36 offen offset:1024 sc1
    s_add_u32 s37, s26, 53248
    s_add_u32 s36, s4, 53248
    buffer_load_dwordx4 v[240:243], v8, s[8:11], s37 offen offset:0 sc1
    buffer_load_dwordx4 v[244:247], v8, s[8:11], s37 offen offset:1024 sc1
    buffer_load_dwordx4 v[248:251], v8, s[8:11], s36 offen offset:0 sc1
    buffer_load_dwordx4 v[252:255], v8, s[8:11], s36 offen offset:1024 sc1
L_c_67:
    v_mfma_f32_16x16x32_bf16 v[120:123], a[104:107], v[84:87], v[120:123]
    ds_read_b64_tr_b16 v[68:69], v13 offset:61440
    v_mfma_f32_16x16x32_bf16 v[124:127], a[108:111], v[84:87], v[124:127]
    ds_read_b64_tr_b16 v[70:71], v13 offset:61952
    s_waitcnt lgkmcnt(12)
    v_mfma_f32_16x16x32_bf16 v[128:131], a[104:107], v[88:91], v[128:131]
    ds_read_b64_tr_b16 v[72:73], v14 offset:61440
    v_mfma_f32_16x16x32_bf16 v[132:135], a[108:111], v[88:91], v[132:135]
    ds_read_b64_tr_b16 v[74:75], v14 offset:61952
    s_lshl_b32 s30, s50, 9
    s_add_u32 s30, s30, s45
    s_add_u32 s30, s30, 8192
    buffer_load_dwordx2 v[24:25], v21, s[8:11], s30 offen offset:0 sc1
    buffer_load_dwordx2 v[26:27], v21, s[8:11], s30 offen offset:128 sc1
    buffer_load_dwordx2 v[28:29], v21, s[8:11], s30 offen offset:256 sc1
    buffer_load_dwordx2 v[30:31], v21, s[8:11], s30 offen offset:384 sc1
    v_mfma_f32_16x16x32_bf16 v[136:139], a[104:107], v[92:95], v[136:139]
    ds_read_b64_tr_b16 v[76:77], v15 offset:61440
    v_mfma_f32_16x16x32_bf16 v[140:143], a[108:111], v[92:95], v[140:143]
    ds_read_b64_tr_b16 v[78:79], v15 offset:61952
    s_waitcnt lgkmcnt(12)
    v_mfma_f32_16x16x32_bf16 v[112:115], a[112:115], v[96:99], v[112:115]
    v_mfma_f32_16x16x32_bf16 v[116:119], a[116:119], v[96:99], v[116:119]
    v_mfma_f32_16x16x32_bf16 v[120:123], a[112:115], v[100:103], v[120:123]
    v_mfma_f32_16x16x32_bf16 v[124:127], a[116:119], v[100:103], v[124:127]
    s_waitcnt lgkmcnt(8)
    v_mfma_f32_16x16x32_bf16 v[128:131], a[112:115], v[104:107], v[128:131]
    v_mfma_f32_16x16x32_bf16 v[132:135], a[116:119], v[104:107], v[132:135]
    v_mfma_f32_16x16x32_bf16 v[136:139], a[112:115], v[108:111], v[136:139]
    v_mfma_f32_16x16x32_bf16 v[140:143], a[116:119], v[108:111], v[140:143]
    s_waitcnt lgkmcnt(4)
    v_mfma_f32_16x16x32_bf16 v[112:115], a[120:123], v[64:67], v[112:115]
    v_mfma_f32_16x16x32_bf16 v[116:119], a[124:127], v[64:67], v[116:119]
    v_mfma_f32_16x16x32_bf16 v[120:123], a[120:123], v[68:71], v[120:123]
    v_mfma_f32_16x16x32_bf16 v[124:127], a[124:127], v[68:71], v[124:127]
    s_waitcnt lgkmcnt(0)
    v_mfma_f32_16x16x32_bf16 v[128:131], a[120:123], v[72:75], v[128:131]
    v_mfma_f32_16x16x32_bf16 v[132:135], a[124:127], v[72:75], v[132:135]
    v_mfma_f32_16x16x32_bf16 v[136:139], a[120:123], v[76:79], v[136:139]
    v_mfma_f32_16x16x32_bf16 v[140:143], a[124:127], v[76:79], v[140:143]
    s_mul_i32 s31, s52, 114688
    s_mul_i32 s19, s33, 28672
    s_add_u32 s31, s31, s19
    s_add_u32 s31, s31, s46
    s_add_u32 s31, s31, 0
    s_lshl_b32 s19, s25, 10
    s_sub_u32 s5, s31, s19
    s_add_u32 s5, s5, 1024
    s_add_u32 s31, s31, s19
    s_cmp_lg_u32 s33, 1
    s_cbranch_scc1 L_spd_69
    s_cmp_lg_u32 s40, 0
    s_cbranch_scc1 L_w_70
    s_waitcnt vmcnt(9)
    s_branch L_w_71
L_w_70:
    s_waitcnt vmcnt(4)
L_w_71:
    v_cmp_le_u32 vcc, 14, v4
    s_nop 1
    s_cmp_eq_u64 vcc, -1
    s_cbranch_scc1 L_spd_69
    s_mov_b32 s18, 200000
    buffer_load_dword v4, v2, s[8:11], s47 offen sc1
    s_sleep 4
L_sp_68:
    buffer_load_dword v4, v2, s[8:11], s47 offen sc1
    s_waitcnt vmcnt(1)
    v_cmp_le_u32 vcc, 14, v4
    s_nop 1
    s_cmp_eq_u64 vcc, -1
    s_cbranch_scc1 L_spd_69
    s_sub_u32 s18, s18, 1
    s_cmp_lg_u32 s18, 0
    s_cbranch_scc1 L_sp_68
L_spd_69:
    s_barrier
    buffer_load_dwordx4 v[64:67], v8, s[8:11], s31 offen offset:0 sc1
    buffer_load_dwordx4 v[68:71], v8, s[8:11], s5 offen offset:0 sc1
    s_mov_b32 s18, 200000
    s_waitcnt vmcnt(2)
L_rs_72:
    v_min3_u32 v6, v24, v26, v28
    v_min_u32 v6, v6, v30
    v_cmp_ne_u32 vcc, 0, v6
    s_nop 1
    s_cmp_eq_u64 vcc, -1
    s_cbranch_scc1 L_rsd_73
    s_sleep 1
    buffer_load_dwordx2 v[24:25], v21, s[8:11], s30 offen offset:0 sc1
    buffer_load_dwordx2 v[26:27], v21, s[8:11], s30 offen offset:128 sc1
    buffer_load_dwordx2 v[28:29], v21, s[8:11], s30 offen offset:256 sc1
    buffer_load_dwordx2 v[30:31], v21, s[8:11], s30 offen offset:384 sc1
    s_waitcnt vmcnt(0)
    s_sub_u32 s18, s18, 1
    s_cmp_lg_u32 s18, 0
    s_cbranch_scc1 L_rs_72
L_rsd_73:
    v_pk_fma_f32 v[48:49], v[32:33], v[24:25], v[40:41] op_sel:[0,1,0] op_sel_hi:[1,1,1] neg_lo:[0,1,0] neg_hi:[0,1,0]
    v_pk_fma_f32 v[50:51], v[34:35], v[24:25], v[42:43] op_sel:[0,1,0] op_sel_hi:[1,1,1] neg_lo:[0,1,0] neg_hi:[0,1,0]
    v_pk_fma_f32 v[52:53], v[36:37], v[24:25], v[44:45] op_sel:[0,1,0] op_sel_hi:[1,1,1] neg_lo:[0,1,0] neg_hi:[0,1,0]
    v_pk_fma_f32 v[54:55], v[38:39], v[24:25], v[46:47] op_sel:[0,1,0] op_sel_hi:[1,1,1] neg_lo:[0,1,0] neg_hi:[0,1,0]
    v_pk_fma_f32 v[56:57], v[32:33], v[26:27], v[40:41] op_sel:[0,1,0] op_sel_hi:[1,1,1] neg_lo:[0,1,0] neg_hi:[0,1,0]
    v_pk_fma_f32 v[58:59], v[34:35], v[26:27], v[42:43] op_sel:[0,1,0] op_sel_hi:[1,1,1] neg_lo:[0,1,0] neg_hi:[0,1,0]
    v_pk_fma_f32 v[60:61], v[36:37], v[26:27], v[44:45] op_sel:[0,1,0] op_sel_hi:[1,1,1] neg_lo:[0,1,0] neg_hi:[0,1,0]
    v_pk_fma_f32 v[62:63], v[38:39], v[26:27], v[46:47] op_sel:[0,1,0] op_sel_hi:[1,1,1] neg_lo:[0,1,0] neg_hi:[0,1,0]
    buffer_load_dwordx4 v[72:75], v8, s[8:11], s31 offen offset:2048 sc1
    buffer_load_dwordx4 v[76:79], v8, s[8:11], s5 offen offset:2048 sc1
    s_add_u32 s31, s31, 4096
    s_add_u32 s5, s5, 4096
    v_pk_fma_f32 v[112:113], v[112:113], v[24:25], v[48:49] op_sel_hi:[1,0,1]
    v_pk_fma_f32 v[114:115], v[114:115], v[24:25], v[50:51] op_sel_hi:[1,0,1]
    v_pk_fma_f32 v[116:117], v[116:117], v[24:25], v[52:53] op_sel_hi:[1,0,1]
    v_pk_fma_f32 v[118:119], v[118:119], v[24:25], v[54:55] op_sel_hi:[1,0,1]
    v_pk_fma_f32 v[120:121], v[120:121], v[26:27], v[56:57] op_sel_hi:[1,0,1]
    v_pk_fma_f32 v[122:123], v[122:123], v[26:27], v[58:59] op_sel_hi:[1,0,1]
    v_pk_fma_f32 v[124:125], v[124:125], v[26:27], v[60:61] op_sel_hi:[1,0,1]
    v_pk_fma_f32 v[126:127], v[126:127], v[26:27], v[62:63] op_sel_hi:[1,0,1]
    buffer_load_dwordx4 v[80:83], v8, s[8:11], s31 offen offset:0 sc1
    buffer_load_dwordx4 v[84:87], v8, s[8:11], s5 offen offset:0 sc1
    v_max_f32 v112, 0, v112
    v_max_f32 v113, 0, v113
    v_max_f32 v114, 0, v114
    v_max_f32 v115, 0, v115
    v_max_f32 v116, 0, v116
    v_max_f32 v117, 0, v117
    v_max_f32 v118, 0, v118
    v_max_f32 v119, 0, v119
    buffer_load_dwordx4 v[88:91], v8, s[8:11], s31 offen offset:2048 sc1
    buffer_load_dwordx4 v[92:95], v8, s[8:11], s5 offen offset:2048 sc1
    s_add_u32 s31, s31, 4096
    s_add_u32 s5, s5, 4096
    v_max_f32 v120, 0, v120
    v_max_f32 v121, 0, v121
    v_max_f32 v122, 0, v122
    v_max_f32 v123, 0, v123
    v_max_f32 v124, 0, v124
    v_max_f32 v125, 0, v125
    v_max_f32 v126, 0, v126
    v_max_f32 v127, 0, v127
    buffer_load_dwordx4 v[96:99], v8, s[8:11], s31 offen offset:0 sc1
    buffer_load_dwordx4 v[100:103], v8, s[8:11], s5 offen offset:0 sc1
    v_pk_mul_f32 v[112:113], v[112:113], v[112:113]
    v_pk_mul_f32 v[114:115], v[114:115], v[114:115]
    v_pk_mul_f32 v[116:117], v[116:117], v[116:117]
    v_pk_mul_f32 v[118:119], v[118:119], v[118:119]
    v_pk_mul_f32 v[120:121], v[120:121], v[120:121]
    v_pk_mul_f32 v[122:123], v[122:123], v[122:123]
    v_pk_mul_f32 v[124:125], v[124:125], v[124:125]
    v_pk_mul_f32 v[126:127], v[126:127], v[126:127]
    buffer_load_dwordx4 v[104:107], v8, s[8:11], s31 offen offset:2048 sc1
    buffer_load_dwordx4 v[108:111], v8, s[8:11], s5 offen offset:2048 sc1
    s_add_u32 s31, s31, 4096
    s_add_u32 s5, s5, 4096
    v_cvt_pk_bf16_f32 v144, v112, v113
    v_cvt_pk_bf16_f32 v145, v114, v115
    v_cvt_pk_bf16_f32 v146, v116, v117
    v_cvt_pk_bf16_f32 v147, v118, v119
    buffer_store_dwordx4 v[144:147], v8, s[8:11], s23 offen offset:0 sc1
    v_cvt_pk_bf16_f32 v148, v120, v121
    v_cvt_pk_bf16_f32 v149, v122, v123
    v_cvt_pk_bf16_f32 v150, v124, v125
    v_cvt_pk_bf16_f32 v151, v126, v127
    buffer_store_dwordx4 v[148:151], v8, s[8:11], s23 offen offset:1024 sc1
    v_pk_fma_f32 v[48:49], v[32:33], v[28:29], v[40:41] op_sel:[0,1,0] op_sel_hi:[1,1,1] neg_lo:[0,1,0] neg_hi:[0,1,0]
    v_pk_fma_f32 v[50:51], v[34:35], v[28:29], v[42:43] op_sel:[0,1,0] op_sel_hi:[1,1,1] neg_lo:[0,1,0] neg_hi:[0,1,0]
    v_pk_fma_f32 v[52:53], v[36:37], v[28:29], v[44:45] op_sel:[0,1,0] op_sel_hi:[1,1,1] neg_lo:[0,1,0] neg_hi:[0,1,0]
    v_pk_fma_f32 v[54:55], v[38:39], v[28:29], v[46:47] op_sel:[0,1,0] op_sel_hi:[1,1,1] neg_lo:[0,1,0] neg_hi:[0,1,0]
    v_pk_fma_f32 v[56:57], v[32:33], v[30:31], v[40:41] op_sel:[0,1,0] op_sel_hi:[1,1,1] neg_lo:[0,1,0] neg_hi:[0,1,0]
    v_pk_fma_f32 v[58:59], v[34:35], v[30:31], v[42:43] op_sel:[0,1,0] op_sel_hi:[1,1,1] neg_lo:[0,1,0] neg_hi:[0,1,0]
    v_pk_fma_f32 v[60:61], v[36:37], v[30:31], v[44:45] op_sel:[0,1,0] op_sel_hi:[1,1,1] neg_lo:[0,1,0] neg_hi:[0,1,0]
    v_pk_fma_f32 v[62:63], v[38:39], v[30:31], v[46:47] op_sel:[0,1,0] op_sel_hi:[1,1,1] neg_lo:[0,1,0] neg_hi:[0,1,0]
    v_pk_fma_f32 v[128:129], v[128:129], v[28:29], v[48:49] op_sel_hi:[1,0,1]
    v_pk_fma_f32 v[130:131], v[130:131], v[28:29], v[50:51] op_sel_hi:[1,0,1]
    v_pk_fma_f32 v[132:133], v[132:133], v[28:29], v[52:53] op_sel_hi:[1,0,1]
    v_pk_fma_f32 v[134:135], v[134:135], v[28:29], v[54:55] op_sel_hi:[1,0,1]
    v_pk_fma_f32 v[136:137], v[136:137], v[30:31], v[56:57] op_sel_hi:[1,0,1]
    v_pk_fma_f32 v[138:139], v[138:139], v[30:31], v[58:59] op_sel_hi:[1,0,1]
    v_pk_fma_f32 v[140:141], v[140:141], v[30:31], v[60:61] op_sel_hi:[1,0,1]
    v_pk_fma_f32 v[142:143], v[142:143], v[30:31], v[62:63] op_sel_hi:[1,0,1]
    v_max_f32 v128, 0, v128
    v_max_f32 v129, 0, v129
    v_max_f32 v130, 0, v130
    v_max_f32 v131, 0, v131
    v_max_f32 v132, 0, v132
    v_max_f32 v133, 0, v133
    v_max_f32 v134, 0, v134
    v_max_f32 v135, 0, v135
    v_max_f32 v136, 0, v136
    v_max_f32 v137, 0, v137
    v_max_f32 v138, 0, v138
    v_max_f32 v139, 0, v139
    v_max_f32 v140, 0, v140
    v_max_f32 v141, 0, v141
    v_max_f32 v142, 0, v142
    v_max_f32 v143, 0, v143
    v_pk_mul_f32 v[128:129], v[128:129], v[128:129]
    v_pk_mul_f32 v[130:131], v[130:131], v[130:131]
    v_pk_mul_f32 v[132:133], v[132:133], v[132:133]
    v_pk_mul_f32 v[134:135], v[134:135], v[134:135]
    v_pk_mul_f32 v[136:137], v[136:137], v[136:137]
    v_pk_mul_f32 v[138:139], v[138:139], v[138:139]
    v_pk_mul_f32 v[140:141], v[140:141], v[140:141]
    v_pk_mul_f32 v[142:143], v[142:143], v[142:143]
    v_cvt_pk_bf16_f32 v152, v128, v129
    v_cvt_pk_bf16_f32 v153, v130, v131
    v_cvt_pk_bf16_f32 v154, v132, v133
    v_cvt_pk_bf16_f32 v155, v134, v135
    buffer_store_dwordx4 v[152:155], v8, s[8:11], s24 offen offset:0 sc1
    v_cvt_pk_bf16_f32 v156, v136, v137
    v_cvt_pk_bf16_f32 v157, v138, v139
    v_cvt_pk_bf16_f32 v158, v140, v141
    v_cvt_pk_bf16_f32 v159, v142, v143
    buffer_store_dwordx4 v[156:159], v8, s[8:11], s24 offen offset:1024 sc1
    s_branch L_g2
L_stats:
    s_sub_u32 s18, s17, 28
    s_lshl_b32 s19, s16, 2
    s_add_u32 s18, s18, s19
    s_add_u32 s18, s18, 0
    s_lshr_b32 s19, s18, 1
    s_lshl_b32 s19, s19, 16
    s_add_u32 s20, s43, s19
    s_and_b32 s19, s18, 1
    s_lshl_b32 s19, s19, 6
    s_add_u32 s20, s20, s19
    s_lshl_b32 s21, s18, 8
    s_add_u32 s21, s21, s45
    v_lshrrev_b32 v9, 2, v0
    v_lshlrev_b32 v9, 7, v9
    v_and_b32 v10, 3, v0
    v_lshl_add_u32 v9, v10, 4, v9
    buffer_load_dwordx4 v[32:35], v9, s[8:11], s20 offen sc1
    s_add_u32 s20, s20, 8192
    buffer_load_dwordx4 v[36:39], v9, s[8:11], s20 offen sc1
    s_add_u32 s20, s20, 8192
    buffer_load_dwordx4 v[40:43], v9, s[8:11], s20 offen sc1
    s_add_u32 s20, s20, 8192
    buffer_load_dwordx4 v[44:47], v9, s[8:11], s20 offen sc1
    s_add_u32 s20, s20, 8192
    buffer_load_dwordx4 v[48:51], v9, s[8:11], s20 offen sc1
    s_add_u32 s20, s20, 8192
    buffer_load_dwordx4 v[52:55], v9, s[8:11], s20 offen sc1
    s_add_u32 s20, s20, 8192
    buffer_load_dwordx4 v[56:59], v9, s[8:11], s20 offen sc1
    s_add_u32 s20, s20, 8192
    buffer_load_dwordx4 v[60:63], v9, s[8:11], s20 offen sc1
    s_waitcnt vmcnt(7)
    v_lshlrev_b32 v112, 16, v32
    v_and_b32 v113, 0xffff0000, v32
    v_lshlrev_b32 v114, 16, v33
    v_and_b32 v115, 0xffff0000, v33
    v_lshlrev_b32 v116, 16, v34
    v_and_b32 v117, 0xffff0000, v34
    v_lshlrev_b32 v118, 16, v35
    v_and_b32 v119, 0xffff0000, v35
    v_mov_b64 v[96:97], v[112:113]
    v_pk_mul_f32 v[104:105], v[112:113], v[112:113]
    v_mov_b64 v[98:99], v[114:115]
    v_pk_mul_f32 v[106:107], v[114:115], v[114:115]
    v_mov_b64 v[100:101], v[116:117]
    v_pk_mul_f32 v[108:109], v[116:117], v[116:117]
    v_mov_b64 v[102:103], v[118:119]
    v_pk_mul_f32 v[110:111], v[118:119], v[118:119]
    s_waitcnt vmcnt(6)
    v_lshlrev_b32 v112, 16, v36
    v_and_b32 v113, 0xffff0000, v36
    v_lshlrev_b32 v114, 16, v37
    v_and_b32 v115, 0xffff0000, v37
    v_lshlrev_b32 v116, 16, v38
    v_and_b32 v117, 0xffff0000, v38
    v_lshlrev_b32 v118, 16, v39
    v_and_b32 v119, 0xffff0000, v39
    v_pk_add_f32 v[96:97], v[96:97], v[112:113]
    v_pk_fma_f32 v[104:105], v[112:113], v[112:113], v[104:105]
    v_pk_add_f32 v[98:99], v[98:99], v[114:115]
    v_pk_fma_f32 v[106:107], v[114:115], v[114:115], v[106:107]
    v_pk_add_f32 v[100:101], v[100:101], v[116:117]
    v_pk_fma_f32 v[108:109], v[116:117], v[116:117], v[108:109]
    v_pk_add_f32 v[102:103], v[102:103], v[118:119]
    v_pk_fma_f32 v[110:111], v[118:119], v[118:119], v[110:111]
    s_waitcnt vmcnt(5)
    v_lshlrev_b32 v112, 16, v40
    v_and_b32 v113, 0xffff0000, v40
    v_lshlrev_b32 v114, 16, v41
    v_and_b32 v115, 0xffff0000, v41
    v_lshlrev_b32 v116, 16, v42
    v_and_b32 v117, 0xffff0000, v42
    v_lshlrev_b32 v118, 16, v43
    v_and_b32 v119, 0xffff0000, v43
    v_pk_add_f32 v[96:97], v[96:97], v[112:113]
    v_pk_fma_f32 v[104:105], v[112:113], v[112:113], v[104:105]
    v_pk_add_f32 v[98:99], v[98:99], v[114:115]
    v_pk_fma_f32 v[106:107], v[114:115], v[114:115], v[106:107]
    v_pk_add_f32 v[100:101], v[100:101], v[116:117]
    v_pk_fma_f32 v[108:109], v[116:117], v[116:117], v[108:109]
    v_pk_add_f32 v[102:103], v[102:103], v[118:119]
    v_pk_fma_f32 v[110:111], v[118:119], v[118:119], v[110:111]
    s_waitcnt vmcnt(4)
    v_lshlrev_b32 v112, 16, v44
    v_and_b32 v113, 0xffff0000, v44
    v_lshlrev_b32 v114, 16, v45
    v_and_b32 v115, 0xffff0000, v45
    v_lshlrev_b32 v116, 16, v46
    v_and_b32 v117, 0xffff0000, v46
    v_lshlrev_b32 v118, 16, v47
    v_and_b32 v119, 0xffff0000, v47
    v_pk_add_f32 v[96:97], v[96:97], v[112:113]
    v_pk_fma_f32 v[104:105], v[112:113], v[112:113], v[104:105]
    v_pk_add_f32 v[98:99], v[98:99], v[114:115]
    v_pk_fma_f32 v[106:107], v[114:115], v[114:115], v[106:107]
    v_pk_add_f32 v[100:101], v[100:101], v[116:117]
    v_pk_fma_f32 v[108:109], v[116:117], v[116:117], v[108:109]
    v_pk_add_f32 v[102:103], v[102:103], v[118:119]
    v_pk_fma_f32 v[110:111], v[118:119], v[118:119], v[110:111]
    s_waitcnt vmcnt(3)
    v_lshlrev_b32 v112, 16, v48
    v_and_b32 v113, 0xffff0000, v48
    v_lshlrev_b32 v114, 16, v49
    v_and_b32 v115, 0xffff0000, v49
    v_lshlrev_b32 v116, 16, v50
    v_and_b32 v117, 0xffff0000, v50
    v_lshlrev_b32 v118, 16, v51
    v_and_b32 v119, 0xffff0000, v51
    v_pk_add_f32 v[96:97], v[96:97], v[112:113]
    v_pk_fma_f32 v[104:105], v[112:113], v[112:113], v[104:105]
    v_pk_add_f32 v[98:99], v[98:99], v[114:115]
    v_pk_fma_f32 v[106:107], v[114:115], v[114:115], v[106:107]
    v_pk_add_f32 v[100:101], v[100:101], v[116:117]
    v_pk_fma_f32 v[108:109], v[116:117], v[116:117], v[108:109]
    v_pk_add_f32 v[102:103], v[102:103], v[118:119]
    v_pk_fma_f32 v[110:111], v[118:119], v[118:119], v[110:111]
    s_waitcnt vmcnt(2)
    v_lshlrev_b32 v112, 16, v52
    v_and_b32 v113, 0xffff0000, v52
    v_lshlrev_b32 v114, 16, v53
    v_and_b32 v115, 0xffff0000, v53
    v_lshlrev_b32 v116, 16, v54
    v_and_b32 v117, 0xffff0000, v54
    v_lshlrev_b32 v118, 16, v55
    v_and_b32 v119, 0xffff0000, v55
    v_pk_add_f32 v[96:97], v[96:97], v[112:113]
    v_pk_fma_f32 v[104:105], v[112:113], v[112:113], v[104:105]
    v_pk_add_f32 v[98:99], v[98:99], v[114:115]
    v_pk_fma_f32 v[106:107], v[114:115], v[114:115], v[106:107]
    v_pk_add_f32 v[100:101], v[100:101], v[116:117]
    v_pk_fma_f32 v[108:109], v[116:117], v[116:117], v[108:109]
    v_pk_add_f32 v[102:103], v[102:103], v[118:119]
    v_pk_fma_f32 v[110:111], v[118:119], v[118:119], v[110:111]
    s_waitcnt vmcnt(1)
    v_lshlrev_b32 v112, 16, v56
    v_and_b32 v113, 0xffff0000, v56
    v_lshlrev_b32 v114, 16, v57
    v_and_b32 v115, 0xffff0000, v57
    v_lshlrev_b32 v116, 16, v58
    v_and_b32 v117, 0xffff0000, v58
    v_lshlrev_b32 v118, 16, v59
    v_and_b32 v119, 0xffff0000, v59
    v_pk_add_f32 v[96:97], v[96:97], v[112:113]
    v_pk_fma_f32 v[104:105], v[112:113], v[112:113], v[104:105]
    v_pk_add_f32 v[98:99], v[98:99], v[114:115]
    v_pk_fma_f32 v[106:107], v[114:115], v[114:115], v[106:107]
    v_pk_add_f32 v[100:101], v[100:101], v[116:117]
    v_pk_fma_f32 v[108:109], v[116:117], v[116:117], v[108:109]
    v_pk_add_f32 v[102:103], v[102:103], v[118:119]
    v_pk_fma_f32 v[110:111], v[118:119], v[118:119], v[110:111]
    s_waitcnt vmcnt(0)
    v_lshlrev_b32 v112, 16, v60
    v_and_b32 v113, 0xffff0000, v60
    v_lshlrev_b32 v114, 16, v61
    v_and_b32 v115, 0xffff0000, v61
    v_lshlrev_b32 v116, 16, v62
    v_and_b32 v117, 0xffff0000, v62
    v_lshlrev_b32 v118, 16, v63
    v_and_b32 v119, 0xffff0000, v63
    v_pk_add_f32 v[96:97], v[96:97], v[112:113]
    v_pk_fma_f32 v[104:105], v[112:113], v[112:113], v[104:105]
    v_pk_add_f32 v[98:99], v[98:99], v[114:115]
    v_pk_fma_f32 v[106:107], v[114:115], v[114:115], v[106:107]
    v_pk_add_f32 v[100:101], v[100:101], v[116:117]
    v_pk_fma_f32 v[108:109], v[116:117], v[116:117], v[108:109]
    v_pk_add_f32 v[102:103], v[102:103], v[118:119]
    v_pk_fma_f32 v[110:111], v[118:119], v[118:119], v[110:111]
    v_permlane32_swap_b32 v96, v104
    v_permlane32_swap_b32 v97, v105
    v_permlane32_swap_b32 v98, v106
    v_permlane32_swap_b32 v99, v107
    v_permlane32_swap_b32 v100, v108
    v_permlane32_swap_b32 v101, v109
    v_permlane32_swap_b32 v102, v110
    v_permlane32_swap_b32 v103, v111
    v_add_f32 v96, v96, v104
    v_add_f32 v97, v97, v105
    v_add_f32 v98, v98, v106
    v_add_f32 v99, v99, v107
    v_add_f32 v100, v100, v108
    v_add_f32 v101, v101, v109
    v_add_f32 v102, v102, v110
    v_add_f32 v103, v103, v111
    v_permlane16_swap_b32 v96, v100
    v_permlane16_swap_b32 v97, v101
    v_permlane16_swap_b32 v98, v102
    v_permlane16_swap_b32 v99, v103
    v_add_f32 v96, v96, v100
    v_add_f32 v97, v97, v101
    v_add_f32 v98, v98, v102
    v_add_f32 v99, v99, v103
    v_add_f32_dpp v96, v96, v96 row_ror:8 row_mask:0xf bank_mask:0xf
    v_add_f32_dpp v97, v97, v97 row_ror:8 row_mask:0xf bank_mask:0xf
    v_add_f32_dpp v98, v98, v98 row_ror:8 row_mask:0xf bank_mask:0xf
    v_add_f32_dpp v99, v99, v99 row_ror:8 row_mask:0xf bank_mask:0xf
    v_add_f32_dpp v96, v96, v96 row_ror:4 row_mask:0xf bank_mask:0xf
    v_add_f32_dpp v97, v97, v97 row_ror:4 row_mask:0xf bank_mask:0xf
    v_add_f32_dpp v98, v98, v98 row_ror:4 row_mask:0xf bank_mask:0xf
    v_add_f32_dpp v99, v99, v99 row_ror:4 row_mask:0xf bank_mask:0xf
    v_lshrrev_b32 v11, 5, v1
    v_lshlrev_b32 v11, 7, v11
    v_lshl_add_u32 v11, v10, 5, v11
    v_bfe_u32 v12, v1, 4, 1
    v_lshl_add_u32 v11, v12, 4, v11
    s_lshl_b32 s18, s33, 8
    s_add_u32 s18, s18, 92160
    v_add_u32 v11, s18, v11
    ds_write_b128 v11, v[96:99]
    v_and_b32 v13, 31, v1
    v_lshlrev_b32 v12, 2, v13
    v_add_u32 v12, 92160, v12
    s_waitcnt lgkmcnt(0)
    s_barrier
    s_cmp_lg_u32 s33, 0
    s_cbranch_scc1 L_ste_74
    ds_read_b32 v16, v12 offset:0
    ds_read_b32 v20, v12 offset:128
    ds_read_b32 v17, v12 offset:256
    ds_read_b32 v21, v12 offset:384
    ds_read_b32 v18, v12 offset:512
    ds_read_b32 v22, v12 offset:640
    ds_read_b32 v19, v12 offset:768
    ds_read_b32 v23, v12 offset:896
    s_waitcnt lgkmcnt(0)
    v_add_f32 v16, v16, v17
    v_add_f32 v18, v18, v19
    v_add_f32 v20, v20, v21
    v_add_f32 v22, v22, v23
    v_add_f32 v16, v16, v18
    v_add_f32 v17, v20, v22
    v_mul_f32 v16, 0x3b000000, v16
    v_mul_f32 v17, 0x3b000000, v17
    v_fma_f32 v17, -v16, v16, v17
    v_max_f32 v17, 0, v17
    v_add_f32 v17, 0x3727c5ac, v17
    v_rsq_f32 v22, v17
    v_lshlrev_b32 v12, 3, v13
    v_mul_f32 v23, v22, v16
    v_or_b32 v22, 1, v22
    s_mov_b32 exec_hi, 0
    buffer_store_dwordx2 v[22:23], v12, s[8:11], s21 offen sc1
    s_mov_b64 exec, -1
L_ste_74:
    s_cmp_lg_u32 s40, 0
    s_cbranch_scc1 L_c_75
    s_add_u32 s37, s26, 16384
    s_add_u32 s36, s4, 16384
    buffer_load_dwordx4 a[192:195], v8, s[8:11], s37 offen offset:0 sc1
    buffer_load_dwordx4 a[196:199], v8, s[8:11], s37 offen offset:1024 sc1
    buffer_load_dwordx4 a[200:203], v8, s[8:11], s36 offen offset:0 sc1
    buffer_load_dwordx4 a[204:207], v8, s[8:11], s36 offen offset:1024 sc1
    s_add_u32 s37, s26, 20480
    s_add_u32 s36, s4, 20480
    buffer_load_dwordx4 a[208:211], v8, s[8:11], s37 offen offset:0 sc1
    buffer_load_dwordx4 a[212:215], v8, s[8:11], s37 offen offset:1024 sc1
    buffer_load_dwordx4 a[216:219], v8, s[8:11], s36 offen offset:0 sc1
    buffer_load_dwordx4 a[220:223], v8, s[8:11], s36 offen offset:1024 sc1
    s_add_u32 s37, s26, 24576
    s_add_u32 s36, s4, 24576
    buffer_load_dwordx4 a[224:227], v8, s[8:11], s37 offen offset:0 sc1
    buffer_load_dwordx4 a[228:231], v8, s[8:11], s37 offen offset:1024 sc1
    buffer_load_dwordx4 a[232:235], v8, s[8:11], s36 offen offset:0 sc1
    buffer_load_dwordx4 a[236:239], v8, s[8:11], s36 offen offset:1024 sc1
    s_add_u32 s37, s26, 28672
    s_add_u32 s36, s4, 28672
    buffer_load_dwordx4 a[240:243], v8, s[8:11], s37 offen offset:0 sc1
    buffer_load_dwordx4 a[244:247], v8, s[8:11], s37 offen offset:1024 sc1
    buffer_load_dwordx4 a[248:251], v8, s[8:11], s36 offen offset:0 sc1
    buffer_load_dwordx4 a[252:255], v8, s[8:11], s36 offen offset:1024 sc1
    s_add_u32 s37, s26, 32768
    s_add_u32 s36, s4, 32768
    buffer_load_dwordx4 v[160:163], v8, s[8:11], s37 offen offset:0 sc1
    buffer_load_dwordx4 v[164:167], v8, s[8:11], s37 offen offset:1024 sc1
    buffer_load_dwordx4 v[168:171], v8, s[8:11], s36 offen offset:0 sc1
    buffer_load_dwordx4 v[172:175], v8, s[8:11], s36 offen offset:1024 sc1
L_c_75:
    s_add_u32 s47, s44, 0x8000
    s_or_b32 s18, s47, s7
    buffer_load_dword v4, v3, s[8:11], s18 offen sc1
    s_cmp_lg_u32 s33, 1
    s_cbranch_scc1 L_spd_77
    s_waitcnt vmcnt(0)
    v_cmp_le_u32 vcc, 16, v4
    s_nop 1
    s_cmp_eq_u64 vcc, -1
    s_cbranch_scc1 L_spd_77
    s_mov_b32 s18, 200000
    buffer_load_dword v4, v3, s[8:11], s47 offen sc1
    s_sleep 4
L_sp_76:
    buffer_load_dword v4, v3, s[8:11], s47 offen sc1
    s_waitcnt vmcnt(1)
    v_cmp_le_u32 vcc, 16, v4
    s_nop 1
    s_cmp_eq_u64 vcc, -1
    s_cbranch_scc1 L_spd_77
    s_sub_u32 s18, s18, 1
    s_cmp_lg_u32 s18, 0
    s_cbranch_scc1 L_sp_76
L_spd_77:
    s_barrier
    s_sub_u32 s18, s17, 28
    s_lshl_b32 s19, s16, 2
    s_add_u32 s18, s18, s19
    s_add_u32 s18, s18, 32
    s_lshr_b32 s19, s18, 1
    s_lshl_b32 s19, s19, 16
    s_add_u32 s20, s43, s19
    s_and_b32 s19, s18, 1
    s_lshl_b32 s19, s19, 6
    s_add_u32 s20, s20, s19
    s_lshl_b32 s21, s18, 8
    s_add_u32 s21, s21, s45
    v_lshrrev_b32 v9, 2, v0
    v_lshlrev_b32 v9, 7, v9
    v_and_b32 v10, 3, v0
    v_lshl_add_u32 v9, v10, 4, v9
    buffer_load_dwordx4 v[32:35], v9, s[8:11], s20 offen sc1
    s_add_u32 s20, s20, 8192
    buffer_load_dwordx4 v[36:39], v9, s[8:11], s20 offen sc1
    s_add_u32 s20, s20, 8192
    buffer_load_dwordx4 v[40:43], v9, s[8:11], s20 offen sc1
    s_add_u32 s20, s20, 8192
    buffer_load_dwordx4 v[44:47], v9, s[8:11], s20 offen sc1
    s_add_u32 s20, s20, 8192
    buffer_load_dwordx4 v[48:51], v9, s[8:11], s20 offen sc1
    s_add_u32 s20, s20, 8192
    buffer_load_dwordx4 v[52:55], v9, s[8:11], s20 offen sc1
    s_add_u32 s20, s20, 8192
    buffer_load_dwordx4 v[56:59], v9, s[8:11], s20 offen sc1
    s_add_u32 s20, s20, 8192
    buffer_load_dwordx4 v[60:63], v9, s[8:11], s20 offen sc1
    s_waitcnt vmcnt(7)
    v_lshlrev_b32 v112, 16, v32
    v_and_b32 v113, 0xffff0000, v32
    v_lshlrev_b32 v114, 16, v33
    v_and_b32 v115, 0xffff0000, v33
    v_lshlrev_b32 v116, 16, v34
    v_and_b32 v117, 0xffff0000, v34
    v_lshlrev_b32 v118, 16, v35
    v_and_b32 v119, 0xffff0000, v35
    v_mov_b64 v[96:97], v[112:113]
    v_pk_mul_f32 v[104:105], v[112:113], v[112:113]
    v_mov_b64 v[98:99], v[114:115]
    v_pk_mul_f32 v[106:107], v[114:115], v[114:115]
    v_mov_b64 v[100:101], v[116:117]
    v_pk_mul_f32 v[108:109], v[116:117], v[116:117]
    v_mov_b64 v[102:103], v[118:119]
    v_pk_mul_f32 v[110:111], v[118:119], v[118:119]
    s_waitcnt vmcnt(6)
    v_lshlrev_b32 v112, 16, v36
    v_and_b32 v113, 0xffff0000, v36
    v_lshlrev_b32 v114, 16, v37
    v_and_b32 v115, 0xffff0000, v37
    v_lshlrev_b32 v116, 16, v38
    v_and_b32 v117, 0xffff0000, v38
    v_lshlrev_b32 v118, 16, v39
    v_and_b32 v119, 0xffff0000, v39
    v_pk_add_f32 v[96:97], v[96:97], v[112:113]
    v_pk_fma_f32 v[104:105], v[112:113], v[112:113], v[104:105]
    v_pk_add_f32 v[98:99], v[98:99], v[114:115]
    v_pk_fma_f32 v[106:107], v[114:115], v[114:115], v[106:107]
    v_pk_add_f32 v[100:101], v[100:101], v[116:117]
    v_pk_fma_f32 v[108:109], v[116:117], v[116:117], v[108:109]
    v_pk_add_f32 v[102:103], v[102:103], v[118:119]
    v_pk_fma_f32 v[110:111], v[118:119], v[118:119], v[110:111]
    s_waitcnt vmcnt(5)
    v_lshlrev_b32 v112, 16, v40
    v_and_b32 v113, 0xffff0000, v40
    v_lshlrev_b32 v114, 16, v41
    v_and_b32 v115, 0xffff0000, v41
    v_lshlrev_b32 v116, 16, v42
    v_and_b32 v117, 0xffff0000, v42
    v_lshlrev_b32 v118, 16, v43
    v_and_b32 v119, 0xffff0000, v43
    v_pk_add_f32 v[96:97], v[96:97], v[112:113]
    v_pk_fma_f32 v[104:105], v[112:113], v[112:113], v[104:105]
    v_pk_add_f32 v[98:99], v[98:99], v[114:115]
    v_pk_fma_f32 v[106:107], v[114:115], v[114:115], v[106:107]
    v_pk_add_f32 v[100:101], v[100:101], v[116:117]
    v_pk_fma_f32 v[108:109], v[116:117], v[116:117], v[108:109]
    v_pk_add_f32 v[102:103], v[102:103], v[118:119]
    v_pk_fma_f32 v[110:111], v[118:119], v[118:119], v[110:111]
    s_waitcnt vmcnt(4)
    v_lshlrev_b32 v112, 16, v44
    v_and_b32 v113, 0xffff0000, v44
    v_lshlrev_b32 v114, 16, v45
    v_and_b32 v115, 0xffff0000, v45
    v_lshlrev_b32 v116, 16, v46
    v_and_b32 v117, 0xffff0000, v46
    v_lshlrev_b32 v118, 16, v47
    v_and_b32 v119, 0xffff0000, v47
    v_pk_add_f32 v[96:97], v[96:97], v[112:113]
    v_pk_fma_f32 v[104:105], v[112:113], v[112:113], v[104:105]
    v_pk_add_f32 v[98:99], v[98:99], v[114:115]
    v_pk_fma_f32 v[106:107], v[114:115], v[114:115], v[106:107]
    v_pk_add_f32 v[100:101], v[100:101], v[116:117]
    v_pk_fma_f32 v[108:109], v[116:117], v[116:117], v[108:109]
    v_pk_add_f32 v[102:103], v[102:103], v[118:119]
    v_pk_fma_f32 v[110:111], v[118:119], v[118:119], v[110:111]
    s_waitcnt vmcnt(3)
    v_lshlrev_b32 v112, 16, v48
    v_and_b32 v113, 0xffff0000, v48
    v_lshlrev_b32 v114, 16, v49
    v_and_b32 v115, 0xffff0000, v49
    v_lshlrev_b32 v116, 16, v50
    v_and_b32 v117, 0xffff0000, v50
    v_lshlrev_b32 v118, 16, v51
    v_and_b32 v119, 0xffff0000, v51
    v_pk_add_f32 v[96:97], v[96:97], v[112:113]
    v_pk_fma_f32 v[104:105], v[112:113], v[112:113], v[104:105]
    v_pk_add_f32 v[98:99], v[98:99], v[114:115]
    v_pk_fma_f32 v[106:107], v[114:115], v[114:115], v[106:107]
    v_pk_add_f32 v[100:101], v[100:101], v[116:117]
    v_pk_fma_f32 v[108:109], v[116:117], v[116:117], v[108:109]
    v_pk_add_f32 v[102:103], v[102:103], v[118:119]
    v_pk_fma_f32 v[110:111], v[118:119], v[118:119], v[110:111]
    s_waitcnt vmcnt(2)
    v_lshlrev_b32 v112, 16, v52
    v_and_b32 v113, 0xffff0000, v52
    v_lshlrev_b32 v114, 16, v53
    v_and_b32 v115, 0xffff0000, v53
    v_lshlrev_b32 v116, 16, v54
    v_and_b32 v117, 0xffff0000, v54
    v_lshlrev_b32 v118, 16, v55
    v_and_b32 v119, 0xffff0000, v55
    v_pk_add_f32 v[96:97], v[96:97], v[112:113]
    v_pk_fma_f32 v[104:105], v[112:113], v[112:113], v[104:105]
    v_pk_add_f32 v[98:99], v[98:99], v[114:115]
    v_pk_fma_f32 v[106:107], v[114:115], v[114:115], v[106:107]
    v_pk_add_f32 v[100:101], v[100:101], v[116:117]
    v_pk_fma_f32 v[108:109], v[116:117], v[116:117], v[108:109]
    v_pk_add_f32 v[102:103], v[102:103], v[118:119]
    v_pk_fma_f32 v[110:111], v[118:119], v[118:119], v[110:111]
    s_waitcnt vmcnt(1)
    v_lshlrev_b32 v112, 16, v56
    v_and_b32 v113, 0xffff0000, v56
    v_lshlrev_b32 v114, 16, v57
    v_and_b32 v115, 0xffff0000, v57
    v_lshlrev_b32 v116, 16, v58
    v_and_b32 v117, 0xffff0000, v58
    v_lshlrev_b32 v118, 16, v59
    v_and_b32 v119, 0xffff0000, v59
    v_pk_add_f32 v[96:97], v[96:97], v[112:113]
    v_pk_fma_f32 v[104:105], v[112:113], v[112:113], v[104:105]
    v_pk_add_f32 v[98:99], v[98:99], v[114:115]
    v_pk_fma_f32 v[106:107], v[114:115], v[114:115], v[106:107]
    v_pk_add_f32 v[100:101], v[100:101], v[116:117]
    v_pk_fma_f32 v[108:109], v[116:117], v[116:117], v[108:109]
    v_pk_add_f32 v[102:103], v[102:103], v[118:119]
    v_pk_fma_f32 v[110:111], v[118:119], v[118:119], v[110:111]
    s_waitcnt vmcnt(0)
    v_lshlrev_b32 v112, 16, v60
    v_and_b32 v113, 0xffff0000, v60
    v_lshlrev_b32 v114, 16, v61
    v_and_b32 v115, 0xffff0000, v61
    v_lshlrev_b32 v116, 16, v62
    v_and_b32 v117, 0xffff0000, v62
    v_lshlrev_b32 v118, 16, v63
    v_and_b32 v119, 0xffff0000, v63
    v_pk_add_f32 v[96:97], v[96:97], v[112:113]
    v_pk_fma_f32 v[104:105], v[112:113], v[112:113], v[104:105]
    v_pk_add_f32 v[98:99], v[98:99], v[114:115]
    v_pk_fma_f32 v[106:107], v[114:115], v[114:115], v[106:107]
    v_pk_add_f32 v[100:101], v[100:101], v[116:117]
    v_pk_fma_f32 v[108:109], v[116:117], v[116:117], v[108:109]
    v_pk_add_f32 v[102:103], v[102:103], v[118:119]
    v_pk_fma_f32 v[110:111], v[118:119], v[118:119], v[110:111]
    v_permlane32_swap_b32 v96, v104
    v_permlane32_swap_b32 v97, v105
    v_permlane32_swap_b32 v98, v106
    v_permlane32_swap_b32 v99, v107
    v_permlane32_swap_b32 v100, v108
    v_permlane32_swap_b32 v101, v109
    v_permlane32_swap_b32 v102, v110
    v_permlane32_swap_b32 v103, v111
    v_add_f32 v96, v96, v104
    v_add_f32 v97, v97, v105
    v_add_f32 v98, v98, v106
    v_add_f32 v99, v99, v107
    v_add_f32 v100, v100, v108
    v_add_f32 v101, v101, v109
    v_add_f32 v102, v102, v110
    v_add_f32 v103, v103, v111
    v_permlane16_swap_b32 v96, v100
    v_permlane16_swap_b32 v97, v101
    v_permlane16_swap_b32 v98, v102
    v_permlane16_swap_b32 v99, v103
    v_add_f32 v96, v96, v100
    v_add_f32 v97, v97, v101
    v_add_f32 v98, v98, v102
    v_add_f32 v99, v99, v103
    v_add_f32_dpp v96, v96, v96 row_ror:8 row_mask:0xf bank_mask:0xf
    v_add_f32_dpp v97, v97, v97 row_ror:8 row_mask:0xf bank_mask:0xf
    v_add_f32_dpp v98, v98, v98 row_ror:8 row_mask:0xf bank_mask:0xf
    v_add_f32_dpp v99, v99, v99 row_ror:8 row_mask:0xf bank_mask:0xf
    v_add_f32_dpp v96, v96, v96 row_ror:4 row_mask:0xf bank_mask:0xf
    v_add_f32_dpp v97, v97, v97 row_ror:4 row_mask:0xf bank_mask:0xf
    v_add_f32_dpp v98, v98, v98 row_ror:4 row_mask:0xf bank_mask:0xf
    v_add_f32_dpp v99, v99, v99 row_ror:4 row_mask:0xf bank_mask:0xf
    v_lshrrev_b32 v11, 5, v1
    v_lshlrev_b32 v11, 7, v11
    v_lshl_add_u32 v11, v10, 5, v11
    v_bfe_u32 v12, v1, 4, 1
    v_lshl_add_u32 v11, v12, 4, v11
    s_lshl_b32 s18, s33, 8
    s_add_u32 s18, s18, 93184
    v_add_u32 v11, s18, v11
    ds_write_b128 v11, v[96:99]
    v_and_b32 v13, 31, v1
    v_lshlrev_b32 v12, 2, v13
    v_add_u32 v12, 93184, v12
    s_waitcnt lgkmcnt(0)
    s_barrier
    s_cmp_lg_u32 s33, 0
    s_cbranch_scc1 L_ste_78
    ds_read_b32 v16, v12 offset:0
    ds_read_b32 v20, v12 offset:128
    ds_read_b32 v17, v12 offset:256
    ds_read_b32 v21, v12 offset:384
    ds_read_b32 v18, v12 offset:512
    ds_read_b32 v22, v12 offset:640
    ds_read_b32 v19, v12 offset:768
    ds_read_b32 v23, v12 offset:896
    s_waitcnt lgkmcnt(0)
    v_add_f32 v16, v16, v17
    v_add_f32 v18, v18, v19
    v_add_f32 v20, v20, v21
    v_add_f32 v22, v22, v23
    v_add_f32 v16, v16, v18
    v_add_f32 v17, v20, v22
    v_mul_f32 v16, 0x3b000000, v16
    v_mul_f32 v17, 0x3b000000, v17
    v_fma_f32 v17, -v16, v16, v17
    v_max_f32 v17, 0, v17
    v_add_f32 v17, 0x3727c5ac, v17
    v_rsq_f32 v22, v17
    v_lshlrev_b32 v12, 3, v13
    v_mul_f32 v23, v22, v16
    v_or_b32 v22, 1, v22
    s_mov_b32 exec_hi, 0
    buffer_store_dwordx2 v[22:23], v12, s[8:11], s21 offen sc1
    s_mov_b64 exec, -1
L_ste_78:
    v_lshrrev_b32 v22, 2, v1
    v_lshlrev_b32 v22, 7, v22
    v_and_b32 v23, 3, v1
    v_lshl_add_u32 v22, v23, 4, v22
    s_lshl_b32 s18, s53, 13
    s_lshr_b32 s19, s52, 1
    s_lshl_b32 s19, s19, 16
    s_add_u32 s18, s18, s19
    s_and_b32 s19, s52, 1
    s_lshl_b32 s19, s19, 6
    s_add_u32 s18, s18, s19
    s_lshl_b32 s19, s33, 11
    s_add_u32 s18, s18, s19
    s_add_u32 s18, s18, s43
    s_lshl_b32 s19, s33, 10
    s_add_u32 m0, s19, 75776
    s_nop 0
    buffer_load_dwordx4 v22, s[8:11], s18 offen sc1 lds
    s_add_u32 m0, s19, 79872
    s_add_u32 s18, s18, 1048576
    buffer_load_dwordx4 v22, s[8:11], s18 offen sc1 lds
    s_cmp_lg_u32 s40, 0
    s_cbranch_scc1 L_c_79
    s_add_u32 s37, s26, 36864
    s_add_u32 s36, s4, 36864
    buffer_load_dwordx4 v[176:179], v8, s[8:11], s37 offen offset:0 sc1
    buffer_load_dwordx4 v[180:183], v8, s[8:11], s37 offen offset:1024 sc1
    buffer_load_dwordx4 v[184:187], v8, s[8:11], s36 offen offset:0 sc1
    buffer_load_dwordx4 v[188:191], v8, s[8:11], s36 offen offset:1024 sc1
    s_add_u32 s37, s26, 40960
    s_add_u32 s36, s4, 40960
    buffer_load_dwordx4 v[192:195], v8, s[8:11], s37 offen offset:0 sc1
    buffer_load_dwordx4 v[196:199], v8, s[8:11], s37 offen offset:1024 sc1
    buffer_load_dwordx4 v[200:203], v8, s[8:11], s36 offen offset:0 sc1
    buffer_load_dwordx4 v[204:207], v8, s[8:11], s36 offen offset:1024 sc1
    s_add_u32 s37, s26, 45056
    s_add_u32 s36, s4, 45056
    buffer_load_dwordx4 v[208:211], v8, s[8:11], s37 offen offset:0 sc1
    buffer_load_dwordx4 v[212:215], v8, s[8:11], s37 offen offset:1024 sc1
    buffer_load_dwordx4 v[216:219], v8, s[8:11], s36 offen offset:0 sc1
    buffer_load_dwordx4 v[220:223], v8, s[8:11], s36 offen offset:1024 sc1
    s_add_u32 s37, s26, 49152
    s_add_u32 s36, s4, 49152
    buffer_load_dwordx4 v[224:227], v8, s[8:11], s37 offen offset:0 sc1
    buffer_load_dwordx4 v[228:231], v8, s[8:11], s37 offen offset:1024 sc1
    buffer_load_dwordx4 v[232:235], v8, s[8:11], s36 offen offset:0 sc1
    buffer_load_dwordx4 v[236:239], v8, s[8:11], s36 offen offset:1024 sc1
    s_add_u32 s37, s26, 53248
    s_add_u32 s36, s4, 53248
    buffer_load_dwordx4 v[240:243], v8, s[8:11], s37 offen offset:0 sc1
    buffer_load_dwordx4 v[244:247], v8, s[8:11], s37 offen offset:1024 sc1
    buffer_load_dwordx4 v[248:251], v8, s[8:11], s36 offen offset:0 sc1
    buffer_load_dwordx4 v[252:255], v8, s[8:11], s36 offen offset:1024 sc1
L_c_79:
    s_lshr_b32 s47, s52, 1
    s_lshl_b32 s47, s47, 11
    s_add_u32 s47, s47, s44
    s_add_u32 s47, s47, 0x10000
    s_or_b32 s18, s47, s7
    buffer_load_dword v4, v2, s[8:11], s18 offen sc1
    s_cmp_lg_u32 s33, 1
    s_cbranch_scc1 L_spd_81
    s_waitcnt vmcnt(0)
    v_cmp_le_u32 vcc, 14, v4
    s_nop 1
    s_cmp_eq_u64 vcc, -1
    s_cbranch_scc1 L_spd_81
    s_mov_b32 s18, 200000
    buffer_load_dword v4, v2, s[8:11], s47 offen sc1
    s_sleep 4
L_sp_80:
    buffer_load_dword v4, v2, s[8:11], s47 offen sc1
    s_waitcnt vmcnt(1)
    v_cmp_le_u32 vcc, 14, v4
    s_nop 1
    s_cmp_eq_u64 vcc, -1
    s_cbranch_scc1 L_spd_81
    s_sub_u32 s18, s18, 1
    s_cmp_lg_u32 s18, 0
    s_cbranch_scc1 L_sp_80
L_spd_81:
    s_barrier
    s_waitcnt vmcnt(0)
    s_mul_i32 s31, s52, 114688
    s_mul_i32 s19, s33, 28672
    s_add_u32 s31, s31, s19
    s_add_u32 s31, s31, s46
    s_add_u32 s31, s31, 0
    s_lshl_b32 s19, s25, 10
    s_sub_u32 s5, s31, s19
    s_add_u32 s5, s5, 1024
    s_add_u32 s31, s31, s19
    buffer_load_dwordx4 v[64:67], v8, s[8:11], s31 offen offset:0 sc1
    buffer_load_dwordx4 v[68:71], v8, s[8:11], s5 offen offset:0 sc1
    buffer_load_dwordx4 v[72:75], v8, s[8:11], s31 offen offset:2048 sc1
    buffer_load_dwordx4 v[76:79], v8, s[8:11], s5 offen offset:2048 sc1
    s_add_u32 s31, s31, 4096
    s_add_u32 s5, s5, 4096
    buffer_load_dwordx4 v[80:83], v8, s[8:11], s31 offen offset:0 sc1
    buffer_load_dwordx4 v[84:87], v8, s[8:11], s5 offen offset:0 sc1
    buffer_load_dwordx4 v[88:91], v8, s[8:11], s31 offen offset:2048 sc1
    buffer_load_dwordx4 v[92:95], v8, s[8:11], s5 offen offset:2048 sc1
    s_add_u32 s31, s31, 4096
    s_add_u32 s5, s5, 4096
    buffer_load_dwordx4 v[96:99], v8, s[8:11], s31 offen offset:0 sc1
    buffer_load_dwordx4 v[100:103], v8, s[8:11], s5 offen offset:0 sc1
    buffer_load_dwordx4 v[104:107], v8, s[8:11], s31 offen offset:2048 sc1
    buffer_load_dwordx4 v[108:111], v8, s[8:11], s5 offen offset:2048 sc1
    s_add_u32 s31, s31, 4096
    s_add_u32 s5, s5, 4096
    buffer_load_dword v4, v2, s[8:11], s44 offen
    buffer_load_dword v4, v2, s[8:11], s44 offen
    buffer_load_dword v4, v2, s[8:11], s44 offen
    buffer_load_dword v4, v2, s[8:11], s44 offen
L_g2:
    v_and_b32 v7, 3, v1
    v_lshrrev_b32 v17, 4, v1
    s_lshl_b32 s22, s33, 10
    s_lshl_b32 s23, s53, 7
    s_lshl_b32 s18, s28, 6
    s_add_u32 s23, s23, s18
    v_lshl_add_u32 v18, v17, 3, s23
    global_load_dwordx2 v[60:61], v18, s[98:99] offset:0
    global_load_dwordx2 v[62:63], v18, s[98:99] offset:32
    v_and_b32 v15, 15, v1
    v_lshrrev_b32 v6, 2, v15
    v_lshl_add_u32 v11, v17, 2, v6
    v_lshlrev_b32 v11, 6, v11
    v_lshl_add_u32 v11, v7, 3, v11
    s_lshl_b32 s18, s28, 11
    s_lshl_b32 s19, s25, 5
    s_add_u32 s18, s18, s19
    s_add_u32 s18, s18, 75776
    v_add_u32 v11, s18, v11
    v_mul_u32_u24 v12, 144, v15
    v_lshl_add_u32 v12, v17, 3, v12
    s_mul_i32 s18, s25, 2304
    s_lshl_b32 s19, s28, 6
    s_add_u32 s18, s18, s19
    s_add_u32 s18, s18, 83968
    v_add_u32 v12, s18, v12
    v_lshl_add_u32 v13, v17, 3, v6
    v_mul_u32_u24 v13, 144, v13
    v_lshl_add_u32 v13, v7, 3, v13
    s_lshl_b32 s18, s33, 5
    s_add_u32 s18, s18, 83968
    v_add_u32 v13, s18, v13
    v_lshlrev_b32 v14, 6, v15
    v_lshl_add_u32 v14, v17, 4, v14
    s_lshl_b32 s29, s52, 15
    s_lshl_b32 s18, s53, 12
    s_add_u32 s29, s29, s18
    s_add_u32 s29, s29, s22
    v_lshrrev_b32 v16, 5, v1
    v_lshlrev_b32 v18, 2, v15
    v_lshl_add_u32 v18, v16, 7, v18
    v_and_b32 v6, 1, v17
    v_lshl_add_u32 v18, v6, 9, v18
    v_add_u32 v18, 94208, v18
    v_and_b32 v15, 31, v1
    v_lshlrev_b32 v15, 2, v15
    v_lshl_add_u32 v15, v16, 13, v15
    s_lshl_b32 s18, s33, 8
    s_add_u32 s18, s18, 94208
    v_lshl_add_u32 v16, v1, 2, s18
    s_xor_b32 s18, s33, 1
    s_mul_i32 s18, s18, 6144
    s_add_u32 s18, s18, 98304
    v_add_u32 v9, s18, v8
    s_xor_b32 s18, s33, 2
    s_mul_i32 s18, s18, 6144
    s_add_u32 s18, s18, 100352
    v_add_u32 v17, s18, v8
    s_xor_b32 s18, s33, 3
    s_mul_i32 s18, s18, 6144
    s_add_u32 s18, s18, 102400
    v_add_u32 v19, s18, v8
    s_mul_i32 s18, s33, 6144
    s_add_u32 s18, s18, 98304
    v_add_u32 v10, s18, v8
    s_lshl_b32 s3, s50, 11
    s_add_u32 s3, s3, s44
    s_add_u32 s3, s3, 0x18000
    s_or_b32 s3, s3, s6
    s_cmp_ge_u32 s17, 28
    s_cselect_b32 s3, 2130706432, s3
    s_waitcnt vmcnt(2)
    s_barrier
    s_mov_b64 exec, 1
    buffer_atomic_add v5, v2, s[8:11], s3 offen sc1
    s_mov_b64 exec, -1
    v_mfma_f32_16x16x32_bf16 v[128:131], a[128:131], v[64:67], 0
    buffer_load_dwordx4 v[112:115], v8, s[8:11], s31 offen offset:0 sc1
    v_mfma_f32_16x16x32_bf16 v[132:135], a[132:135], v[64:67], 0
    v_mfma_f32_16x16x32_bf16 v[136:139], a[136:139], v[64:67], 0
    buffer_load_dwordx4 v[116:119], v8, s[8:11], s5 offen offset:0 sc1
    v_mfma_f32_16x16x32_bf16 v[140:143], a[140:143], v[64:67], 0
    v_mfma_f32_16x16x32_bf16 v[144:147], a[128:131], v[68:71], 0
    buffer_load_dwordx4 v[120:123], v8, s[8:11], s31 offen offset:2048 sc1
    v_mfma_f32_16x16x32_bf16 v[148:151], a[132:135], v[68:71], 0
    v_mfma_f32_16x16x32_bf16 v[152:155], a[136:139], v[68:71], 0
    buffer_load_dwordx4 v[124:127], v8, s[8:11], s5 offen offset:2048 sc1
    s_add_u32 s31, s31, 4096
    s_add_u32 s5, s5, 4096
    v_mfma_f32_16x16x32_bf16 v[156:159], a[140:143], v[68:71], 0
    v_mfma_f32_16x16x32_bf16 v[128:131], a[144:147], v[72:75], v[128:131]
    buffer_load_dwordx4 v[64:67], v8, s[8:11], s31 offen offset:0 sc1
    v_mfma_f32_16x16x32_bf16 v[132:135], a[148:151], v[72:75], v[132:135]
    v_mfma_f32_16x16x32_bf16 v[136:139], a[152:155], v[72:75], v[136:139]
    v_mfma_f32_16x16x32_bf16 v[140:143], a[156:159], v[72:75], v[140:143]
    v_mfma_f32_16x16x32_bf16 v[144:147], a[144:147], v[76:79], v[144:147]
    buffer_load_dwordx4 v[68:71], v8, s[8:11], s5 offen offset:0 sc1
    v_mfma_f32_16x16x32_bf16 v[148:151], a[148:151], v[76:79], v[148:151]
    v_mfma_f32_16x16x32_bf16 v[152:155], a[152:155], v[76:79], v[152:155]
    v_mfma_f32_16x16x32_bf16 v[156:159], a[156:159], v[76:79], v[156:159]
    v_mfma_f32_16x16x32_bf16 v[128:131], a[160:163], v[80:83], v[128:131]
    buffer_load_dwordx4 v[72:75], v8, s[8:11], s31 offen offset:2048 sc1
    v_mfma_f32_16x16x32_bf16 v[132:135], a[164:167], v[80:83], v[132:135]
    v_mfma_f32_16x16x32_bf16 v[136:139], a[168:171], v[80:83], v[136:139]
    v_mfma_f32_16x16x32_bf16 v[140:143], a[172:175], v[80:83], v[140:143]
    v_mfma_f32_16x16x32_bf16 v[144:147], a[160:163], v[84:87], v[144:147]
    buffer_load_dwordx4 v[76:79], v8, s[8:11], s5 offen offset:2048 sc1
    s_add_u32 s31, s31, 4096
    s_add_u32 s5, s5, 4096
    v_mfma_f32_16x16x32_bf16 v[148:151], a[164:167], v[84:87], v[148:151]
    v_mfma_f32_16x16x32_bf16 v[152:155], a[168:171], v[84:87], v[152:155]
    v_mfma_f32_16x16x32_bf16 v[156:159], a[172:175], v[84:87], v[156:159]
    v_mfma_f32_16x16x32_bf16 v[128:131], a[176:179], v[88:91], v[128:131]
    buffer_load_dwordx4 v[80:83], v8, s[8:11], s31 offen offset:0 sc1
    v_mfma_f32_16x16x32_bf16 v[132:135], a[180:183], v[88:91], v[132:135]
    v_mfma_f32_16x16x32_bf16 v[136:139], a[184:187], v[88:91], v[136:139]
    v_mfma_f32_16x16x32_bf16 v[140:143], a[188:191], v[88:91], v[140:143]
    v_mfma_f32_16x16x32_bf16 v[144:147], a[176:179], v[92:95], v[144:147]
    buffer_load_dwordx4 v[84:87], v8, s[8:11], s5 offen offset:0 sc1
    v_mfma_f32_16x16x32_bf16 v[148:151], a[180:183], v[92:95], v[148:151]
    v_mfma_f32_16x16x32_bf16 v[152:155], a[184:187], v[92:95], v[152:155]
    v_mfma_f32_16x16x32_bf16 v[156:159], a[188:191], v[92:95], v[156:159]
    v_mfma_f32_16x16x32_bf16 v[128:131], a[192:195], v[96:99], v[128:131]
    buffer_load_dwordx4 v[88:91], v8, s[8:11], s31 offen offset:2048 sc1
    v_mfma_f32_16x16x32_bf16 v[132:135], a[196:199], v[96:99], v[132:135]
    v_mfma_f32_16x16x32_bf16 v[136:139], a[200:203], v[96:99], v[136:139]
    v_mfma_f32_16x16x32_bf16 v[140:143], a[204:207], v[96:99], v[140:143]
    v_mfma_f32_16x16x32_bf16 v[144:147], a[192:195], v[100:103], v[144:147]
    buffer_load_dwordx4 v[92:95], v8, s[8:11], s5 offen offset:2048 sc1
    s_add_u32 s31, s31, 4096
    s_add_u32 s5, s5, 4096
    v_mfma_f32_16x16x32_bf16 v[148:151], a[196:199], v[100:103], v[148:151]
    v_mfma_f32_16x16x32_bf16 v[152:155], a[200:203], v[100:103], v[152:155]
    v_mfma_f32_16x16x32_bf16 v[156:159], a[204:207], v[100:103], v[156:159]
    v_mfma_f32_16x16x32_bf16 v[128:131], a[208:211], v[104:107], v[128:131]
    buffer_load_dwordx4 v[96:99], v8, s[8:11], s31 offen offset:0 sc1
    v_mfma_f32_16x16x32_bf16 v[132:135], a[212:215], v[104:107], v[132:135]
    v_mfma_f32_16x16x32_bf16 v[136:139], a[216:219], v[104:107], v[136:139]
    v_mfma_f32_16x16x32_bf16 v[140:143], a[220:223], v[104:107], v[140:143]
    v_mfma_f32_16x16x32_bf16 v[144:147], a[208:211], v[108:111], v[144:147]
    buffer_load_dwordx4 v[100:103], v8, s[8:11], s5 offen offset:0 sc1
    v_mfma_f32_16x16x32_bf16 v[148:151], a[212:215], v[108:111], v[148:151]
    v_mfma_f32_16x16x32_bf16 v[152:155], a[216:219], v[108:111], v[152:155]
    v_mfma_f32_16x16x32_bf16 v[156:159], a[220:223], v[108:111], v[156:159]
    s_waitcnt vmcnt(13)
    v_mfma_f32_16x16x32_bf16 v[128:131], a[224:227], v[112:115], v[128:131]
    buffer_load_dwordx4 v[104:107], v8, s[8:11], s31 offen offset:2048 sc1
    v_mfma_f32_16x16x32_bf16 v[132:135], a[228:231], v[112:115], v[132:135]
    v_mfma_f32_16x16x32_bf16 v[136:139], a[232:235], v[112:115], v[136:139]
    v_mfma_f32_16x16x32_bf16 v[140:143], a[236:239], v[112:115], v[140:143]
    s_waitcnt vmcnt(13)
    v_mfma_f32_16x16x32_bf16 v[144:147], a[224:227], v[116:119], v[144:147]
    buffer_load_dwordx4 v[108:111], v8, s[8:11], s5 offen offset:2048 sc1
    s_add_u32 s31, s31, 4096
    s_add_u32 s5, s5, 4096
    v_mfma_f32_16x16x32_bf16 v[148:151], a[228:231], v[116:119], v[148:151]
    v_mfma_f32_16x16x32_bf16 v[152:155], a[232:235], v[116:119], v[152:155]
    v_mfma_f32_16x16x32_bf16 v[156:159], a[236:239], v[116:119], v[156:159]
    s_waitcnt vmcnt(13)
    v_mfma_f32_16x16x32_bf16 v[128:131], a[240:243], v[120:123], v[128:131]
    v_mfma_f32_16x16x32_bf16 v[132:135], a[244:247], v[120:123], v[132:135]
    v_mfma_f32_16x16x32_bf16 v[136:139], a[248:251], v[120:123], v[136:139]
    v_mfma_f32_16x16x32_bf16 v[140:143], a[252:255], v[120:123], v[140:143]
    s_waitcnt vmcnt(12)
    v_mfma_f32_16x16x32_bf16 v[144:147], a[240:243], v[124:127], v[144:147]
    v_mfma_f32_16x16x32_bf16 v[148:151], a[244:247], v[124:127], v[148:151]
    v_mfma_f32_16x16x32_bf16 v[152:155], a[248:251], v[124:127], v[152:155]
    v_mfma_f32_16x16x32_bf16 v[156:159], a[252:255], v[124:127], v[156:159]
    s_waitcnt vmcnt(11)
    v_mfma_f32_16x16x32_bf16 v[128:131], v[160:163], v[64:67], v[128:131]
    v_mfma_f32_16x16x32_bf16 v[132:135], v[164:167], v[64:67], v[132:135]
    v_mfma_f32_16x16x32_bf16 v[136:139], v[168:171], v[64:67], v[136:139]
    v_mfma_f32_16x16x32_bf16 v[140:143], v[172:175], v[64:67], v[140:143]
    ds_read_b64_tr_b16 v[28:29], v11 offset:0
    ds_read_b64_tr_b16 v[30:31], v11 offset:1024
    v_lshlrev_b32 v20, 16, v60
    v_and_b32 v21, 0xffff0000, v60
    v_lshlrev_b32 v22, 16, v61
    v_and_b32 v23, 0xffff0000, v61
    v_lshlrev_b32 v24, 16, v62
    v_and_b32 v25, 0xffff0000, v62
    v_lshlrev_b32 v26, 16, v63
    v_and_b32 v27, 0xffff0000, v63
    s_waitcnt vmcnt(10)
    v_mfma_f32_16x16x32_bf16 v[144:147], v[160:163], v[68:71], v[144:147]
    v_mfma_f32_16x16x32_bf16 v[148:151], v[164:167], v[68:71], v[148:151]
    v_mfma_f32_16x16x32_bf16 v[152:155], v[168:171], v[68:71], v[152:155]
    v_mfma_f32_16x16x32_bf16 v[156:159], v[172:175], v[68:71], v[156:159]
    s_waitcnt vmcnt(9)
    v_mfma_f32_16x16x32_bf16 v[128:131], v[176:179], v[72:75], v[128:131]
    v_mfma_f32_16x16x32_bf16 v[132:135], v[180:183], v[72:75], v[132:135]
    v_mfma_f32_16x16x32_bf16 v[136:139], v[184:187], v[72:75], v[136:139]
    v_mfma_f32_16x16x32_bf16 v[140:143], v[188:191], v[72:75], v[140:143]
    s_waitcnt vmcnt(8)
    v_mfma_f32_16x16x32_bf16 v[144:147], v[176:179], v[76:79], v[144:147]
    v_mfma_f32_16x16x32_bf16 v[148:151], v[180:183], v[76:79], v[148:151]
    v_mfma_f32_16x16x32_bf16 v[152:155], v[184:187], v[76:79], v[152:155]
    v_mfma_f32_16x16x32_bf16 v[156:159], v[188:191], v[76:79], v[156:159]
    s_waitcnt lgkmcnt(0)
    v_lshlrev_b32 v32, 16, v28
    v_and_b32 v33, 0xffff0000, v28
    v_add_f32 v32, v32, v20
    v_add_f32 v33, v33, v21
    v_lshlrev_b32 v34, 16, v29
    v_and_b32 v35, 0xffff0000, v29
    v_add_f32 v34, v34, v22
    v_add_f32 v35, v35, v23
    s_waitcnt vmcnt(7)
    v_mfma_f32_16x16x32_bf16 v[128:131], v[192:195], v[80:83], v[128:131]
    v_mfma_f32_16x16x32_bf16 v[132:135], v[196:199], v[80:83], v[132:135]
    v_mfma_f32_16x16x32_bf16 v[136:139], v[200:203], v[80:83], v[136:139]
    v_mfma_f32_16x16x32_bf16 v[140:143], v[204:207], v[80:83], v[140:143]
    s_waitcnt vmcnt(6)
    v_mfma_f32_16x16x32_bf16 v[144:147], v[192:195], v[84:87], v[144:147]
    v_mfma_f32_16x16x32_bf16 v[148:151], v[196:199], v[84:87], v[148:151]
    v_mfma_f32_16x16x32_bf16 v[152:155], v[200:203], v[84:87], v[152:155]
    v_mfma_f32_16x16x32_bf16 v[156:159], v[204:207], v[84:87], v[156:159]
    v_lshlrev_b32 v36, 16, v30
    v_and_b32 v37, 0xffff0000, v30
    v_add_f32 v36, v36, v24
    v_add_f32 v37, v37, v25
    v_lshlrev_b32 v38, 16, v31
    v_and_b32 v39, 0xffff0000, v31
    v_add_f32 v38, v38, v26
    v_add_f32 v39, v39, v27
    s_waitcnt vmcnt(5)
    v_mfma_f32_16x16x32_bf16 v[128:131], v[208:211], v[88:91], v[128:131]
    v_mfma_f32_16x16x32_bf16 v[132:135], v[212:215], v[88:91], v[132:135]
    v_mfma_f32_16x16x32_bf16 v[136:139], v[216:219], v[88:91], v[136:139]
    v_mfma_f32_16x16x32_bf16 v[140:143], v[220:223], v[88:91], v[140:143]
    s_waitcnt vmcnt(4)
    v_mfma_f32_16x16x32_bf16 v[144:147], v[208:211], v[92:95], v[144:147]
    v_mfma_f32_16x16x32_bf16 v[148:151], v[212:215], v[92:95], v[148:151]
    v_mfma_f32_16x16x32_bf16 v[152:155], v[216:219], v[92:95], v[152:155]
    v_mfma_f32_16x16x32_bf16 v[156:159], v[220:223], v[92:95], v[156:159]
    s_waitcnt vmcnt(3)
    v_mfma_f32_16x16x32_bf16 v[128:131], v[224:227], v[96:99], v[128:131]
    v_mfma_f32_16x16x32_bf16 v[132:135], v[228:231], v[96:99], v[132:135]
    v_mfma_f32_16x16x32_bf16 v[136:139], v[232:235], v[96:99], v[136:139]
    v_mfma_f32_16x16x32_bf16 v[140:143], v[236:239], v[96:99], v[140:143]
    s_add_u32 s47, s47, 0x8000
    s_or_b32 s18, s47, s7
    buffer_load_dword v4, v2, s[8:11], s18 offen sc1
    s_waitcnt vmcnt(3)
    v_mfma_f32_16x16x32_bf16 v[144:147], v[224:227], v[100:103], v[144:147]
    v_mfma_f32_16x16x32_bf16 v[148:151], v[228:231], v[100:103], v[148:151]
    v_mfma_f32_16x16x32_bf16 v[152:155], v[232:235], v[100:103], v[152:155]
    v_mfma_f32_16x16x32_bf16 v[156:159], v[236:239], v[100:103], v[156:159]
    s_waitcnt vmcnt(2)
    v_mfma_f32_16x16x32_bf16 v[128:131], v[240:243], v[104:107], v[128:131]
    v_mfma_f32_16x16x32_bf16 v[132:135], v[244:247], v[104:107], v[132:135]
    v_mfma_f32_16x16x32_bf16 v[136:139], v[248:251], v[104:107], v[136:139]
    v_mfma_f32_16x16x32_bf16 v[140:143], v[252:255], v[104:107], v[140:143]
    s_waitcnt vmcnt(1)
    v_mfma_f32_16x16x32_bf16 v[144:147], v[240:243], v[108:111], v[144:147]
    v_mfma_f32_16x16x32_bf16 v[148:151], v[244:247], v[108:111], v[148:151]
    v_mfma_f32_16x16x32_bf16 v[152:155], v[248:251], v[108:111], v[152:155]
    v_mfma_f32_16x16x32_bf16 v[156:159], v[252:255], v[108:111], v[156:159]
    s_mul_i32 s31, s52, 114688
    s_mul_i32 s19, s33, 28672
    s_add_u32 s31, s31, s19
    s_add_u32 s31, s31, s46
    s_add_u32 s31, s31, 3670016
    s_lshl_b32 s19, s25, 10
    s_sub_u32 s5, s31, s19
    s_add_u32 s5, s5, 1024
    s_add_u32 s31, s31, s19
    s_cmp_lg_u32 s33, 1
    s_cbranch_scc1 L_spd_83
    s_waitcnt vmcnt(0)
    v_cmp_le_u32 vcc, 14, v4
    s_nop 1
    s_cmp_eq_u64 vcc, -1
    s_cbranch_scc1 L_spd_83
    s_mov_b32 s18, 200000
    buffer_load_dword v4, v2, s[8:11], s47 offen sc1
    s_sleep 4
L_sp_82:
    buffer_load_dword v4, v2, s[8:11], s47 offen sc1
    s_waitcnt vmcnt(1)
    v_cmp_le_u32 vcc, 14, v4
    s_nop 1
    s_cmp_eq_u64 vcc, -1
    s_cbranch_scc1 L_spd_83
    s_sub_u32 s18, s18, 1
    s_cmp_lg_u32 s18, 0
    s_cbranch_scc1 L_sp_82
L_spd_83:
    s_barrier
    buffer_load_dwordx4 v[112:115], v8, s[8:11], s31 offen offset:0 sc1
    buffer_load_dwordx4 v[116:119], v8, s[8:11], s5 offen offset:0 sc1
    buffer_load_dwordx4 v[120:123], v8, s[8:11], s31 offen offset:2048 sc1
    buffer_load_dwordx4 v[124:127], v8, s[8:11], s5 offen offset:2048 sc1
    s_add_u32 s31, s31, 4096
    s_add_u32 s5, s5, 4096
    s_nop 3
    ds_write_b128 v9, v[136:139] offset:0
    ds_write_b128 v9, v[140:143] offset:1024
    ds_write_b128 v17, v[144:147] offset:0
    ds_write_b128 v17, v[148:151] offset:1024
    ds_write_b128 v19, v[152:155] offset:0
    ds_write_b128 v19, v[156:159] offset:1024
    v_pk_add_f32 v[32:33], v[128:129], v[32:33]
    v_pk_add_f32 v[34:35], v[130:131], v[34:35]
    v_pk_add_f32 v[36:37], v[132:133], v[36:37]
    v_pk_add_f32 v[38:39], v[134:135], v[38:39]
    buffer_load_dwordx4 v[64:67], v8, s[8:11], s31 offen offset:0 sc1
    buffer_load_dwordx4 v[68:71], v8, s[8:11], s5 offen offset:0 sc1
    buffer_load_dwordx4 v[72:75], v8, s[8:11], s31 offen offset:2048 sc1
    s_waitcnt lgkmcnt(0)
    s_barrier
    ds_read_b128 v[40:43], v10 offset:0
    ds_read_b128 v[44:47], v10 offset:1024
    ds_read_b128 v[48:51], v10 offset:2048
    ds_read_b128 v[52:55], v10 offset:3072
    ds_read_b128 v[56:59], v10 offset:4096
    ds_read_b128 v[60:63], v10 offset:5120
    buffer_load_dwordx4 v[76:79], v8, s[8:11], s5 offen offset:2048 sc1
    s_add_u32 s31, s31, 4096
    s_add_u32 s5, s5, 4096
    buffer_load_dwordx4 v[80:83], v8, s[8:11], s31 offen offset:0 sc1
    buffer_load_dwordx4 v[84:87], v8, s[8:11], s5 offen offset:0 sc1
    s_waitcnt lgkmcnt(2)
    v_pk_add_f32 v[40:41], v[40:41], v[48:49]
    v_pk_add_f32 v[42:43], v[42:43], v[50:51]
    v_pk_add_f32 v[44:45], v[44:45], v[52:53]
    v_pk_add_f32 v[46:47], v[46:47], v[54:55]
    s_waitcnt lgkmcnt(0)
    v_pk_add_f32 v[32:33], v[32:33], v[56:57]
    v_pk_add_f32 v[34:35], v[34:35], v[58:59]
    v_pk_add_f32 v[36:37], v[36:37], v[60:61]
    v_pk_add_f32 v[38:39], v[38:39], v[62:63]
    v_pk_add_f32 v[32:33], v[32:33], v[40:41]
    v_pk_add_f32 v[34:35], v[34:35], v[42:43]
    v_pk_add_f32 v[36:37], v[36:37], v[44:45]
    v_pk_add_f32 v[38:39], v[38:39], v[46:47]
    v_cvt_pk_bf16_f32 v28, v32, v33
    v_cvt_pk_bf16_f32 v29, v34, v35
    v_cvt_pk_bf16_f32 v30, v36, v37
    v_cvt_pk_bf16_f32 v31, v38, v39
    ds_write_b64 v12, v[28:29] offset:0
    ds_write_b64 v12, v[30:31] offset:32
    buffer_load_dwordx4 v[88:91], v8, s[8:11], s31 offen offset:2048 sc1
    buffer_load_dwordx4 v[92:95], v8, s[8:11], s5 offen offset:2048 sc1
    s_add_u32 s31, s31, 4096
    s_add_u32 s5, s5, 4096
    buffer_load_dwordx4 v[96:99], v8, s[8:11], s31 offen offset:0 sc1
    s_cmp_eq_u32 s40, 1
    s_cbranch_scc1 L_fin_84
    v_mov_b32 v6, 0
    v_mov_b32 v7, 0
    v_dot2c_f32_bf16 v6, 0x3f803f80, v28
    v_dot2c_f32_bf16 v7, v28, v28
    v_dot2c_f32_bf16 v6, 0x3f803f80, v29
    v_dot2c_f32_bf16 v7, v29, v29
    v_dot2c_f32_bf16 v6, 0x3f803f80, v30
    v_dot2c_f32_bf16 v7, v30, v30
    v_dot2c_f32_bf16 v6, 0x3f803f80, v31
    v_dot2c_f32_bf16 v7, v31, v31
    s_lshl_b32 s18, s52, 7
    s_add_u32 s18, s18, 23789568
    s_or_b32 s18, s18, s6
    v_permlane32_swap_b32 v6, v7
    s_add_u32 s19, s29, 4194304
    v_add_f32 v6, v6, v7
    ds_write_b32 v16, v6
    s_waitcnt lgkmcnt(0)
    s_barrier
    ds_read_b64_tr_b16 v[40:41], v13 offset:0
    ds_read_b64_tr_b16 v[42:43], v13 offset:576
    ds_read2_b32 v[44:45], v18 offset0:0 offset1:16
    ds_read2_b32 v[46:47], v18 offset0:64 offset1:80
    s_waitcnt lgkmcnt(2)
    buffer_store_dwordx4 v[40:43], v14, s[8:11], s19 offen sc1
    s_waitcnt lgkmcnt(0)
    v_add_f32 v44, v44, v45
    v_add_f32 v46, v46, v47
    v_add_f32 v44, v44, v46
    buffer_atomic_add_f32 v44, v15, s[8:11], s18 offen
    s_branch L_fdone_85
L_fin_84:
    v_lshrrev_b32 v6, 3, v0
    v_and_b32 v7, 7, v0
    v_lshlrev_b32 v47, 10, v6
    v_lshl_add_u32 v47, v7, 4, v47
    v_mul_u32_u24 v6, 144, v6
    v_lshl_add_u32 v6, v7, 4, v6
    v_add_u32 v6, 83968, v6
    s_lshl_b32 s18, s52, 15
    s_lshl_b32 s19, s53, 7
    s_add_u32 s18, s18, s19
    s_add_u32 s18, s18, 0
    s_waitcnt lgkmcnt(0)
    s_barrier
    ds_read_b128 v[40:43], v6
    s_waitcnt lgkmcnt(0)
    buffer_store_dwordx4 v[40:43], v47, s[12:15], s18 offen sc1
    s_nop 0
    buffer_load_dword v4, v2, s[8:11], s44 offen
L_fdone_85:
    s_waitcnt vmcnt(14)
    v_mfma_f32_16x16x32_bf16 v[128:131], a[128:131], v[112:115], 0
    buffer_load_dwordx4 v[100:103], v8, s[8:11], s5 offen offset:0 sc1
    v_mfma_f32_16x16x32_bf16 v[132:135], a[132:135], v[112:115], 0
    v_mfma_f32_16x16x32_bf16 v[136:139], a[136:139], v[112:115], 0
    buffer_load_dwordx4 v[104:107], v8, s[8:11], s31 offen offset:2048 sc1
    v_mfma_f32_16x16x32_bf16 v[140:143], a[140:143], v[112:115], 0
    s_waitcnt vmcnt(15)
    v_mfma_f32_16x16x32_bf16 v[144:147], a[128:131], v[116:119], 0
    buffer_load_dwordx4 v[108:111], v8, s[8:11], s5 offen offset:2048 sc1
    s_add_u32 s31, s31, 4096
    s_add_u32 s5, s5, 4096
    v_mfma_f32_16x16x32_bf16 v[148:151], a[132:135], v[116:119], 0
    v_mfma_f32_16x16x32_bf16 v[152:155], a[136:139], v[116:119], 0
    v_mfma_f32_16x16x32_bf16 v[156:159], a[140:143], v[116:119], 0
    s_waitcnt vmcnt(15)
    v_mfma_f32_16x16x32_bf16 v[128:131], a[144:147], v[120:123], v[128:131]
    buffer_load_dwordx4 v[112:115], v8, s[8:11], s31 offen offset:0 sc1
    v_mfma_f32_16x16x32_bf16 v[132:135], a[148:151], v[120:123], v[132:135]
    v_mfma_f32_16x16x32_bf16 v[136:139], a[152:155], v[120:123], v[136:139]
    v_mfma_f32_16x16x32_bf16 v[140:143], a[156:159], v[120:123], v[140:143]
    s_waitcnt vmcnt(15)
    v_mfma_f32_16x16x32_bf16 v[144:147], a[144:147], v[124:127], v[144:147]
    buffer_load_dwordx4 v[116:119], v8, s[8:11], s5 offen offset:0 sc1
    v_mfma_f32_16x16x32_bf16 v[148:151], a[148:151], v[124:127], v[148:151]
    v_mfma_f32_16x16x32_bf16 v[152:155], a[152:155], v[124:127], v[152:155]
    v_mfma_f32_16x16x32_bf16 v[156:159], a[156:159], v[124:127], v[156:159]
    s_waitcnt vmcnt(15)
    v_mfma_f32_16x16x32_bf16 v[128:131], a[160:163], v[64:67], v[128:131]
    buffer_load_dwordx4 v[120:123], v8, s[8:11], s31 offen offset:2048 sc1
    v_mfma_f32_16x16x32_bf16 v[132:135], a[164:167], v[64:67], v[132:135]
    v_mfma_f32_16x16x32_bf16 v[136:139], a[168:171], v[64:67], v[136:139]
    v_mfma_f32_16x16x32_bf16 v[140:143], a[172:175], v[64:67], v[140:143]
    s_waitcnt vmcnt(15)
    v_mfma_f32_16x16x32_bf16 v[144:147], a[160:163], v[68:71], v[144:147]
    buffer_load_dwordx4 v[124:127], v8, s[8:11], s5 offen offset:2048 sc1
    s_add_u32 s31, s31, 4096
    s_add_u32 s5, s5, 4096
    v_mfma_f32_16x16x32_bf16 v[148:151], a[164:167], v[68:71], v[148:151]
    v_mfma_f32_16x16x32_bf16 v[152:155], a[168:171], v[68:71], v[152:155]
    v_mfma_f32_16x16x32_bf16 v[156:159], a[172:175], v[68:71], v[156:159]
    s_waitcnt vmcnt(15)
    v_mfma_f32_16x16x32_bf16 v[128:131], a[176:179], v[72:75], v[128:131]
    buffer_load_dwordx4 v[64:67], v8, s[8:11], s31 offen offset:0 sc1
    v_mfma_f32_16x16x32_bf16 v[132:135], a[180:183], v[72:75], v[132:135]
    v_mfma_f32_16x16x32_bf16 v[136:139], a[184:187], v[72:75], v[136:139]
    v_mfma_f32_16x16x32_bf16 v[140:143], a[188:191], v[72:75], v[140:143]
    s_waitcnt vmcnt(15)
    v_mfma_f32_16x16x32_bf16 v[144:147], a[176:179], v[76:79], v[144:147]
    buffer_load_dwordx4 v[68:71], v8, s[8:11], s5 offen offset:0 sc1
    v_mfma_f32_16x16x32_bf16 v[148:151], a[180:183], v[76:79], v[148:151]
    v_mfma_f32_16x16x32_bf16 v[152:155], a[184:187], v[76:79], v[152:155]
    v_mfma_f32_16x16x32_bf16 v[156:159], a[188:191], v[76:79], v[156:159]
    s_waitcnt vmcnt(15)
    v_mfma_f32_16x16x32_bf16 v[128:131], a[192:195], v[80:83], v[128:131]
    buffer_load_dwordx4 v[72:75], v8, s[8:11], s31 offen offset:2048 sc1
    v_mfma_f32_16x16x32_bf16 v[132:135], a[196:199], v[80:83], v[132:135]
    v_mfma_f32_16x16x32_bf16 v[136:139], a[200:203], v[80:83], v[136:139]
    v_mfma_f32_16x16x32_bf16 v[140:143], a[204:207], v[80:83], v[140:143]
    s_waitcnt vmcnt(15)
    v_mfma_f32_16x16x32_bf16 v[144:147], a[192:195], v[84:87], v[144:147]
    buffer_load_dwordx4 v[76:79], v8, s[8:11], s5 offen offset:2048 sc1
    s_add_u32 s31, s31, 4096
    s_add_u32 s5, s5, 4096
    v_mfma_f32_16x16x32_bf16 v[148:151], a[196:199], v[84:87], v[148:151]
    v_mfma_f32_16x16x32_bf16 v[152:155], a[200:203], v[84:87], v[152:155]
    v_mfma_f32_16x16x32_bf16 v[156:159], a[204:207], v[84:87], v[156:159]
    s_add_u32 s3, s27, 31784960
    s_or_b32 s3, s3, s6
    s_cmp_eq_u32 s40, 1
    s_cselect_b32 s3, 2130706432, s3
    s_cmp_lg_u32 s40, 0
    s_cbranch_scc1 L_o_86
    s_waitcnt vmcnt(11)
    s_barrier
L_o_86:
    s_mov_b64 exec, 1
    buffer_atomic_add v5, v2, s[8:11], s3 offen sc1
    s_mov_b64 exec, -1
    s_waitcnt vmcnt(16)
    v_mfma_f32_16x16x32_bf16 v[128:131], a[208:211], v[88:91], v[128:131]
    buffer_load_dwordx4 v[80:83], v8, s[8:11], s31 offen offset:0 sc1
    v_mfma_f32_16x16x32_bf16 v[132:135], a[212:215], v[88:91], v[132:135]
    v_mfma_f32_16x16x32_bf16 v[136:139], a[216:219], v[88:91], v[136:139]
    v_mfma_f32_16x16x32_bf16 v[140:143], a[220:223], v[88:91], v[140:143]
    s_waitcnt vmcnt(16)
    v_mfma_f32_16x16x32_bf16 v[144:147], a[208:211], v[92:95], v[144:147]
    buffer_load_dwordx4 v[84:87], v8, s[8:11], s5 offen offset:0 sc1
    v_mfma_f32_16x16x32_bf16 v[148:151], a[212:215], v[92:95], v[148:151]
    v_mfma_f32_16x16x32_bf16 v[152:155], a[216:219], v[92:95], v[152:155]
    v_mfma_f32_16x16x32_bf16 v[156:159], a[220:223], v[92:95], v[156:159]
    s_waitcnt vmcnt(16)
    v_mfma_f32_16x16x32_bf16 v[128:131], a[224:227], v[96:99], v[128:131]
    buffer_load_dwordx4 v[88:91], v8, s[8:11], s31 offen offset:2048 sc1
    v_mfma_f32_16x16x32_bf16 v[132:135], a[228:231], v[96:99], v[132:135]
    v_mfma_f32_16x16x32_bf16 v[136:139], a[232:235], v[96:99], v[136:139]
    v_mfma_f32_16x16x32_bf16 v[140:143], a[236:239], v[96:99], v[140:143]
    s_waitcnt vmcnt(14)
    v_mfma_f32_16x16x32_bf16 v[144:147], a[224:227], v[100:103], v[144:147]
    buffer_load_dwordx4 v[92:95], v8, s[8:11], s5 offen offset:2048 sc1
    s_add_u32 s31, s31, 4096
    s_add_u32 s5, s5, 4096
    v_mfma_f32_16x16x32_bf16 v[148:151], a[228:231], v[100:103], v[148:151]
    v_mfma_f32_16x16x32_bf16 v[152:155], a[232:235], v[100:103], v[152:155]
    v_mfma_f32_16x16x32_bf16 v[156:159], a[236:239], v[100:103], v[156:159]
    s_waitcnt vmcnt(14)
    v_mfma_f32_16x16x32_bf16 v[128:131], a[240:243], v[104:107], v[128:131]
    v_mfma_f32_16x16x32_bf16 v[132:135], a[244:247], v[104:107], v[132:135]
    v_mfma_f32_16x16x32_bf16 v[136:139], a[248:251], v[104:107], v[136:139]
    v_mfma_f32_16x16x32_bf16 v[140:143], a[252:255], v[104:107], v[140:143]
    s_waitcnt vmcnt(13)
    v_mfma_f32_16x16x32_bf16 v[144:147], a[240:243], v[108:111], v[144:147]
    v_mfma_f32_16x16x32_bf16 v[148:151], a[244:247], v[108:111], v[148:151]
    v_mfma_f32_16x16x32_bf16 v[152:155], a[248:251], v[108:111], v[152:155]
    v_mfma_f32_16x16x32_bf16 v[156:159], a[252:255], v[108:111], v[156:159]
    s_waitcnt vmcnt(12)
    v_mfma_f32_16x16x32_bf16 v[128:131], v[160:163], v[112:115], v[128:131]
    v_mfma_f32_16x16x32_bf16 v[132:135], v[164:167], v[112:115], v[132:135]
    v_mfma_f32_16x16x32_bf16 v[136:139], v[168:171], v[112:115], v[136:139]
    v_mfma_f32_16x16x32_bf16 v[140:143], v[172:175], v[112:115], v[140:143]
    ds_read_b64_tr_b16 v[28:29], v11 offset:4096
    ds_read_b64_tr_b16 v[30:31], v11 offset:5120
    s_waitcnt vmcnt(11)
    v_mfma_f32_16x16x32_bf16 v[144:147], v[160:163], v[116:119], v[144:147]
    v_mfma_f32_16x16x32_bf16 v[148:151], v[164:167], v[116:119], v[148:151]
    v_mfma_f32_16x16x32_bf16 v[152:155], v[168:171], v[116:119], v[152:155]
    v_mfma_f32_16x16x32_bf16 v[156:159], v[172:175], v[116:119], v[156:159]
    s_waitcnt vmcnt(10)
    v_mfma_f32_16x16x32_bf16 v[128:131], v[176:179], v[120:123], v[128:131]
    v_mfma_f32_16x16x32_bf16 v[132:135], v[180:183], v[120:123], v[132:135]
    v_mfma_f32_16x16x32_bf16 v[136:139], v[184:187], v[120:123], v[136:139]
    v_mfma_f32_16x16x32_bf16 v[140:143], v[188:191], v[120:123], v[140:143]
    s_waitcnt vmcnt(9)
    v_mfma_f32_16x16x32_bf16 v[144:147], v[176:179], v[124:127], v[144:147]
    v_mfma_f32_16x16x32_bf16 v[148:151], v[180:183], v[124:127], v[148:151]
    v_mfma_f32_16x16x32_bf16 v[152:155], v[184:187], v[124:127], v[152:155]
    v_mfma_f32_16x16x32_bf16 v[156:159], v[188:191], v[124:127], v[156:159]
    s_waitcnt lgkmcnt(0)
    v_lshlrev_b32 v32, 16, v28
    v_and_b32 v33, 0xffff0000, v28
    v_add_f32 v32, v32, v20
    v_add_f32 v33, v33, v21
    v_lshlrev_b32 v34, 16, v29
    v_and_b32 v35, 0xffff0000, v29
    v_add_f32 v34, v34, v22
    v_add_f32 v35, v35, v23
    s_waitcnt vmcnt(8)
    v_mfma_f32_16x16x32_bf16 v[128:131], v[192:195], v[64:67], v[128:131]
    v_mfma_f32_16x16x32_bf16 v[132:135], v[196:199], v[64:67], v[132:135]
    v_mfma_f32_16x16x32_bf16 v[136:139], v[200:203], v[64:67], v[136:139]
    v_mfma_f32_16x16x32_bf16 v[140:143], v[204:207], v[64:67], v[140:143]
    s_waitcnt vmcnt(7)
    v_mfma_f32_16x16x32_bf16 v[144:147], v[192:195], v[68:71], v[144:147]
    v_mfma_f32_16x16x32_bf16 v[148:151], v[196:199], v[68:71], v[148:151]
    v_mfma_f32_16x16x32_bf16 v[152:155], v[200:203], v[68:71], v[152:155]
    v_mfma_f32_16x16x32_bf16 v[156:159], v[204:207], v[68:71], v[156:159]
    v_lshlrev_b32 v36, 16, v30
    v_and_b32 v37, 0xffff0000, v30
    v_add_f32 v36, v36, v24
    v_add_f32 v37, v37, v25
    v_lshlrev_b32 v38, 16, v31
    v_and_b32 v39, 0xffff0000, v31
    v_add_f32 v38, v38, v26
    v_add_f32 v39, v39, v27
    s_waitcnt vmcnt(6)
    v_mfma_f32_16x16x32_bf16 v[128:131], v[208:211], v[72:75], v[128:131]
    v_mfma_f32_16x16x32_bf16 v[132:135], v[212:215], v[72:75], v[132:135]
    v_mfma_f32_16x16x32_bf16 v[136:139], v[216:219], v[72:75], v[136:139]
    v_mfma_f32_16x16x32_bf16 v[140:143], v[220:223], v[72:75], v[140:143]
    s_waitcnt vmcnt(5)
    v_mfma_f32_16x16x32_bf16 v[144:147], v[208:211], v[76:79], v[144:147]
    v_mfma_f32_16x16x32_bf16 v[148:151], v[212:215], v[76:79], v[148:151]
    v_mfma_f32_16x16x32_bf16 v[152:155], v[216:219], v[76:79], v[152:155]
    v_mfma_f32_16x16x32_bf16 v[156:159], v[220:223], v[76:79], v[156:159]
    s_waitcnt vmcnt(3)
    v_mfma_f32_16x16x32_bf16 v[128:131], v[224:227], v[80:83], v[128:131]
    v_mfma_f32_16x16x32_bf16 v[132:135], v[228:231], v[80:83], v[132:135]
    v_mfma_f32_16x16x32_bf16 v[136:139], v[232:235], v[80:83], v[136:139]
    v_mfma_f32_16x16x32_bf16 v[140:143], v[236:239], v[80:83], v[140:143]
    v_and_b32 v6, 15, v1
    v_lshlrev_b32 v6, 10, v6
    v_bfe_u32 v7, v1, 4, 1
    v_lshl_add_u32 v6, v7, 5, v6
    v_lshrrev_b32 v7, 5, v1
    v_lshl_add_u32 v6, v7, 4, v6
    s_lshl_b32 s3, s52, 15
    s_lshl_b32 s19, s53, 7
    s_add_u32 s3, s3, s19
    s_lshl_b32 s19, s28, 6
    s_add_u32 s3, s3, s19
    s_lshl_b32 s19, s25, 14
    s_add_u32 s3, s3, s19
    s_add_u32 s3, s3, 0x100000
    s_waitcnt vmcnt(2)
    v_mfma_f32_16x16x32_bf16 v[144:147], v[224:227], v[84:87], v[144:147]
    v_mfma_f32_16x16x32_bf16 v[148:151], v[228:231], v[84:87], v[148:151]
    v_mfma_f32_16x16x32_bf16 v[152:155], v[232:235], v[84:87], v[152:155]
    v_mfma_f32_16x16x32_bf16 v[156:159], v[236:239], v[84:87], v[156:159]
    s_waitcnt vmcnt(1)
    v_mfma_f32_16x16x32_bf16 v[128:131], v[240:243], v[88:91], v[128:131]
    v_mfma_f32_16x16x32_bf16 v[132:135], v[244:247], v[88:91], v[132:135]
    v_mfma_f32_16x16x32_bf16 v[136:139], v[248:251], v[88:91], v[136:139]
    v_mfma_f32_16x16x32_bf16 v[140:143], v[252:255], v[88:91], v[140:143]
    s_waitcnt vmcnt(0)
    v_mfma_f32_16x16x32_bf16 v[144:147], v[240:243], v[92:95], v[144:147]
    v_mfma_f32_16x16x32_bf16 v[148:151], v[244:247], v[92:95], v[148:151]
    v_mfma_f32_16x16x32_bf16 v[152:155], v[248:251], v[92:95], v[152:155]
    v_mfma_f32_16x16x32_bf16 v[156:159], v[252:255], v[92:95], v[156:159]
    s_nop 3
    ds_write_b128 v9, v[136:139] offset:32768
    ds_write_b128 v9, v[140:143] offset:33792
    ds_write_b128 v17, v[144:147] offset:32768
    ds_write_b128 v17, v[148:151] offset:33792
    ds_write_b128 v19, v[152:155] offset:32768
    ds_write_b128 v19, v[156:159] offset:33792
    v_pk_add_f32 v[32:33], v[128:129], v[32:33]
    v_pk_add_f32 v[34:35], v[130:131], v[34:35]
    v_pk_add_f32 v[36:37], v[132:133], v[36:37]
    v_pk_add_f32 v[38:39], v[134:135], v[38:39]
    s_waitcnt lgkmcnt(0)
    s_barrier
    ds_read_b128 v[40:43], v10 offset:32768
    ds_read_b128 v[44:47], v10 offset:33792
    ds_read_b128 v[48:51], v10 offset:34816
    ds_read_b128 v[52:55], v10 offset:35840
    ds_read_b128 v[56:59], v10 offset:36864
    ds_read_b128 v[60:63], v10 offset:37888
    s_waitcnt lgkmcnt(2)
    v_pk_add_f32 v[40:41], v[40:41], v[48:49]
    v_pk_add_f32 v[42:43], v[42:43], v[50:51]
    v_pk_add_f32 v[44:45], v[44:45], v[52:53]
    v_pk_add_f32 v[46:47], v[46:47], v[54:55]
    s_waitcnt lgkmcnt(0)
    v_pk_add_f32 v[32:33], v[32:33], v[56:57]
    v_pk_add_f32 v[34:35], v[34:35], v[58:59]
    v_pk_add_f32 v[36:37], v[36:37], v[60:61]
    v_pk_add_f32 v[38:39], v[38:39], v[62:63]
    v_pk_add_f32 v[32:33], v[32:33], v[40:41]
    v_pk_add_f32 v[34:35], v[34:35], v[42:43]
    v_pk_add_f32 v[36:37], v[36:37], v[44:45]
    v_pk_add_f32 v[38:39], v[38:39], v[46:47]
    v_cvt_pk_bf16_f32 v28, v32, v33
    v_cvt_pk_bf16_f32 v29, v34, v35
    v_cvt_pk_bf16_f32 v30, v36, v37
    v_cvt_pk_bf16_f32 v31, v38, v39
    s_cmp_eq_u32 s40, 0
    s_cbranch_scc1 L_nf_87
    v_permlane16_swap_b32 v28, v30
    v_permlane16_swap_b32 v29, v31
    buffer_store_dwordx4 v[28:31], v6, s[12:15], s3 offen sc1
    s_branch L_done
L_nf_87:
    ds_write_b64 v12, v[28:29] offset:4608
    ds_write_b64 v12, v[30:31] offset:4640
    s_cmp_eq_u32 s40, 1
    s_cbranch_scc1 L_fin_88
    v_mov_b32 v6, 0
    v_mov_b32 v7, 0
    v_dot2c_f32_bf16 v6, 0x3f803f80, v28
    v_dot2c_f32_bf16 v7, v28, v28
    v_dot2c_f32_bf16 v6, 0x3f803f80, v29
    v_dot2c_f32_bf16 v7, v29, v29
    v_dot2c_f32_bf16 v6, 0x3f803f80, v30
    v_dot2c_f32_bf16 v7, v30, v30
    v_dot2c_f32_bf16 v6, 0x3f803f80, v31
    v_dot2c_f32_bf16 v7, v31, v31
    s_lshl_b32 s18, s52, 7
    s_add_u32 s18, s18, 23793664
    s_or_b32 s18, s18, s6
    v_permlane32_swap_b32 v6, v7
    s_add_u32 s19, s29, 5242880
    v_add_f32 v6, v6, v7
    ds_write_b32 v16, v6
    s_waitcnt lgkmcnt(0)
    s_barrier
    ds_read_b64_tr_b16 v[40:41], v13 offset:4608
    ds_read_b64_tr_b16 v[42:43], v13 offset:5184
    ds_read2_b32 v[44:45], v18 offset0:0 offset1:16
    ds_read2_b32 v[46:47], v18 offset0:64 offset1:80
    s_waitcnt lgkmcnt(2)
    buffer_store_dwordx4 v[40:43], v14, s[8:11], s19 offen sc1
    s_waitcnt lgkmcnt(0)
    v_add_f32 v44, v44, v45
    v_add_f32 v46, v46, v47
    v_add_f32 v44, v44, v46
    buffer_atomic_add_f32 v44, v15, s[8:11], s18 offen
    s_branch L_fdone_89
L_fin_88:
    v_lshrrev_b32 v6, 3, v0
    v_and_b32 v7, 7, v0
    v_lshlrev_b32 v47, 10, v6
    v_lshl_add_u32 v47, v7, 4, v47
    v_mul_u32_u24 v6, 144, v6
    v_lshl_add_u32 v6, v7, 4, v6
    v_add_u32 v6, 88576, v6
    s_lshl_b32 s18, s52, 15
    s_lshl_b32 s19, s53, 7
    s_add_u32 s18, s18, s19
    s_add_u32 s18, s18, 1048576
    s_waitcnt lgkmcnt(0)
    s_barrier
    ds_read_b128 v[40:43], v6
    s_waitcnt lgkmcnt(0)
    buffer_store_dwordx4 v[40:43], v47, s[12:15], s18 offen sc1
    s_nop 0
    buffer_load_dword v4, v2, s[8:11], s44 offen
L_fdone_89:
    s_cmp_eq_u32 s40, 1
    s_cbranch_scc1 L_done
    s_mov_b32 s41, 4194304
    s_mov_b32 s42, 23789568
    v_lshrrev_b32 v138, 3, v0
    v_lshlrev_b32 v138, 15, v138
    v_and_b32 v6, 7, v0
    v_lshl_add_u32 v138, v6, 3, v138
    v_lshlrev_b32 v139, 4, v0
    s_lshl_b32 s20, s2, 7
    s_add_u32 s20, s20, s41
    s_add_u32 s20, s20, 0
    s_add_u32 s21, s42, 0
    s_add_u32 s24, s21, 8192
    s_mov_b32 s47, 31784960
    s_or_b32 s18, s47, s7
    buffer_load_dword v4, v3, s[8:11], s18 offen sc1
    v_mov_b32 v36, 0
    v_mov_b32 v37, 0
    v_mov_b32 v38, 0
    v_mov_b32 v39, 0
    s_cmp_lg_u32 s33, 0
    s_cbranch_scc1 L_cvz_90
    v_lshrrev_b32 v6, 2, v1
    v_and_b32 v7, 3, v1
    v_mul_u32_u24 v9, 4160, v6
    v_lshl_add_u32 v9, v7, 4, v9
    ds_write_b128 v9, v[36:39] offset:4096
L_cvz_90:
    s_cmp_lg_u32 s33, 1
    s_cbranch_scc1 L_cvz_91
    v_lshrrev_b32 v6, 5, v1
    v_mul_u32_u24 v9, 4096, v6
    v_add_u32 v9, v9, v8
    v_add_u32 v9, 66560, v9
    ds_write_b128 v9, v[36:39]
L_cvz_91:
    v_and_b32 v10, 15, v1
    v_lshrrev_b32 v11, 4, v1
    v_and_b32 v132, 7, v1
    v_mul_u32_u24 v132, 4160, v132
    v_bfe_u32 v6, v1, 3, 1
    v_sub_u32 v6, v11, v6
    v_lshl_add_u32 v132, v6, 4, v132
    s_mul_i32 s30, s25, 33280
    s_lshl_b32 s31, s28, 8
    s_sub_u32 s30, s30, s31
    s_add_u32 s30, s30, 272
    v_add_u32 v132, s30, v132
    v_lshlrev_b32 v133, 5, v10
    v_lshl_add_u32 v133, v11, 4, v133
    s_mul_i32 s30, s25, 4608
    s_sub_u32 s30, s30, s31
    s_add_u32 s30, s30, 66848
    v_add_u32 v133, s30, v133
    v_lshlrev_b32 v134, 6, v10
    v_lshl_add_u32 v134, v11, 4, v134
    s_lshl_b32 s30, s25, 12
    s_lshl_b32 s31, s28, 11
    s_add_u32 s30, s30, s31
    s_add_u32 s30, s30, 75776
    v_add_u32 v134, s30, v134
    s_lshl_b32 s30, s33, 11
    s_add_u32 s30, s30, 83968
    v_add_u32 v135, s30, v8
    s_xor_b32 s30, s33, 1
    s_lshl_b32 s30, s30, 11
    s_add_u32 s30, s30, 83968
    v_add_u32 v136, s30, v8
    v_lshrrev_b32 v137, 2, v10
    v_and_b32 v6, 1, v11
    v_lshl_add_u32 v137, v6, 2, v137
    v_lshlrev_b32 v137, 16, v137
    v_and_b32 v6, 3, v10
    v_lshl_add_u32 v137, v6, 5, v137
    v_lshrrev_b32 v6, 5, v1
    v_lshl_add_u32 v137, v6, 4, v137
    v_lshlrev_b32 v140, 3, v0
    v_add_u32 v140, 67072, v140
    v_lshlrev_b32 v141, 4, v0
    v_add_u32 v141, 75776, v141
    s_add_u32 s3, s27, 31817728
    s_or_b32 s3, s3, s6
    s_waitcnt vmcnt(1)
    s_barrier
    s_mov_b64 exec, 1
    buffer_atomic_add v5, v2, s[8:11], s3 offen sc1
    s_mov_b64 exec, -1
    s_cmp_lg_u32 s33, 1
    s_cbranch_scc1 L_spd_93
    s_waitcnt vmcnt(1)
    v_cmp_le_u32 vcc, 16, v4
    s_nop 1
    s_cmp_eq_u64 vcc, -1
    s_cbranch_scc1 L_spd_93
    s_mov_b32 s18, 200000
    buffer_load_dword v4, v3, s[8:11], s47 offen sc1
    s_sleep 4
L_sp_92:
    buffer_load_dword v4, v3, s[8:11], s47 offen sc1
    s_waitcnt vmcnt(1)
    v_cmp_le_u32 vcc, 16, v4
    s_nop 1
    s_cmp_eq_u64 vcc, -1
    s_cbranch_scc1 L_spd_93
    s_sub_u32 s18, s18, 1
    s_cmp_lg_u32 s18, 0
    s_cbranch_scc1 L_sp_92
L_spd_93:
    s_barrier
    buffer_load_dwordx4 v[144:147], v139, s[8:11], s21 offen sc1
    buffer_load_dwordx4 v[148:151], v139, s[8:11], s24 offen sc1
    buffer_load_dwordx2 v[152:153], v138, s[8:11], s20 offen sc1
    buffer_load_dwordx2 v[154:155], v138, s[8:11], s20 offen offset:64 sc1
    buffer_load_dword v4, v2, s[8:11], s44 offen
    buffer_load_dword v4, v2, s[8:11], s44 offen
    s_mov_b32 s40, 1
    s_mov_b32 s43, 6291456
    s_mov_b32 s44, 31981568
    s_mov_b32 s45, 23822336
    s_mov_b32 s46, 24117248
    s_branch L_layer
L_done:
L_mega_end:
    s_endpgm
.section .rodata,"a"
.p2align 6
.amdhsa_kernel interleave_layers__ssm_conv_s4__dense_activation_squared_relu__prompt_kernel
  .amdhsa_next_free_vgpr 512
  .amdhsa_next_free_sgpr 102
  .amdhsa_accum_offset 256
  .amdhsa_group_segment_fixed_size 0
  .amdhsa_kernarg_size 136
  .amdhsa_user_sgpr_count 2
  .amdhsa_user_sgpr_kernarg_segment_ptr 1
  .amdhsa_system_sgpr_workgroup_id_x 1
.end_amdhsa_kernel
```
